```python
import torch

def _softmax(x, axis=-1):
    return torch.softmax(x, dim=axis)
def _gelu(x):
    return torch.nn.functional.gelu(x, approximate="tanh")
def _silu(x):
    return torch.nn.functional.silu(x)
def _sigmoid(x):
    return torch.sigmoid(x)
def _layernorm(x, axis=-1, eps=1e-5):
    m = x.mean(dim=axis, keepdim=True)
    v = x.var(dim=axis, keepdim=True, unbiased=False)
    return (x - m) / torch.sqrt(v + eps)
def _scatter_add(tgt, idx, src, axis=0):
    return tgt.clone().index_add_(axis, idx, src)
def _segment_sum(src, seg, n):
    out = torch.zeros((n,) + src.shape[1:], dtype=src.dtype)
    return out.index_add_(0, seg, src)
def _pad(x, pw):
    flat = tuple(v for pair in reversed(pw) for v in pair)
    return torch.nn.functional.pad(x, flat)

kernel_name = 'recurrent_scan__linear_kernel_hedgehog__glu_gated_reglu__prompt'

def setup_inputs():

    _w = (lambda a: (lambda t: t.to(torch.bfloat16) if t.is_floating_point() else t)(torch.as_tensor(a)))
    def _A_setup():
        B, S, D, H = 1, 2048, 512, 32
        Dh = D // H
        return {
            "x": _w((lambda *s: torch.randn(*s, dtype=torch.bfloat16) * 0.05)(B, S, D)),
            "wqkv": _w((lambda *s: torch.randn(*s, dtype=torch.bfloat16) * 0.8)(D, 3 * D)),
            "w_phi": _w((lambda *s: torch.randn(*s, dtype=torch.bfloat16) * 0.8)(H, Dh, Dh) * (Dh ** -0.5)),
            "wo": _w((lambda *s: torch.randn(*s, dtype=torch.bfloat16) * 0.8)(D, D)),
        }
    _A_in = _A_setup()

    def _B_setup():
        B, S, D, F = 1, 2048, 512, 1376
        return {
            "x": _w((lambda *s: torch.randn(*s, dtype=torch.bfloat16) * 0.05)(B, S, D)),
            "W_gate": _w((lambda *s: torch.randn(*s, dtype=torch.bfloat16) * 0.2)(D, F) * (2.0 / D) ** 0.5),
            "W_up": _w((lambda *s: torch.randn(*s, dtype=torch.bfloat16) * 0.2)(D, F) * (2.0 / D) ** 0.5),
            "W_down": _w((lambda *s: torch.randn(*s, dtype=torch.bfloat16) * 0.2)(F, D) * (1.0 / F) ** 0.5),
        }
    _B_in = _B_setup()

    return {
        "A_x": _A_in["x"],
        "A_wqkv": _A_in["wqkv"],
        "A_w_phi": _A_in["w_phi"],
        "A_wo": _A_in["wo"],
        "B_x": _B_in["x"],
        "B_W_gate": _B_in["W_gate"],
        "B_W_up": _B_in["W_up"],
        "B_W_down": _B_in["W_down"],
    }

def reference(A_x, A_wqkv, A_w_phi, A_wo, B_x, B_W_gate, B_W_up, B_W_down):
    def _A_ref(x, wqkv, w_phi, wo):
        B, S, D = x.shape
        H = 32; Dh = D // H
        qkv = (lambda x, *d: x.permute(*d))((x @ wqkv).reshape(B, S, 3, H, Dh), 2, 0, 3, 1, 4)
        q, k, v = qkv[0], qkv[1], qkv[2]
        pq = torch.einsum("bhsd,hdf->bhsf", q, w_phi)
        pk = torch.einsum("bhsd,hdf->bhsf", k, w_phi)
        phi_q = torch.concatenate([_softmax(pq, axis=-1), _softmax(-pq, axis=-1)], axis=-1)
        phi_k = torch.concatenate([_softmax(pk, axis=-1), _softmax(-pk, axis=-1)], axis=-1)
        kv = torch.einsum("bhsf,bhsd->bhfd", phi_k, v)
        z  = torch.einsum("bhsf->bhf", phi_k)
        num = torch.einsum("bhqf,bhfd->bhqd", phi_q, kv)
        den = torch.einsum("bhqf,bhf->bhq", phi_q, z)[..., None] + 1e-6
        o = num / den
        return (lambda x, *d: x.permute(*d))(o, 0, 2, 1, 3).reshape(B, S, D) @ wo

    def _B_ref(x, W_gate, W_up, W_down):
        gate = torch.einsum("bsd,df->bsf", x, W_gate)
        up = torch.einsum("bsd,df->bsf", x, W_up)
        gate = gate * (lambda x, dt: x.to(dt))(gate > 0, gate.dtype)
        h = gate * up
        return torch.einsum("bsf,fd->bsd", h, W_down)

    x = A_x
    xn = _layernorm(x, axis=-1)
    s = _A_ref(xn, A_wqkv, A_w_phi, A_wo)
    g = _silu(_B_ref(xn, B_W_gate, B_W_up, B_W_down))
    return x + s * g
```

```asm
; @launch grid=(256,1,1) block=(256,1,1) lds=163840
.amdgcn_target "amdgcn-amd-amdhsa--gfx950"
.text
.globl recurrent_scan__linear_kernel_hedgehog__glu_gated_reglu__prompt_kernel
.p2align 8
.type recurrent_scan__linear_kernel_hedgehog__glu_gated_reglu__prompt_kernel,@function
recurrent_scan__linear_kernel_hedgehog__glu_gated_reglu__prompt_kernel:
L_code0:
  s_cmp_ge_u32 s2, 256
  s_cbranch_scc1 L_end
  s_load_dwordx2 s[8:9], s[0:1], 0
  s_load_dwordx2 s[12:13], s[0:1], 8
  s_load_dwordx2 s[28:29], s[0:1], 16
  s_load_dwordx2 s[36:37], s[0:1], 24
  s_load_dwordx2 s[16:17], s[0:1], 40
  s_load_dwordx2 s[20:21], s[0:1], 48
  s_load_dwordx2 s[32:33], s[0:1], 56
  s_load_dwordx2 s[40:41], s[0:1], 64
  s_load_dwordx2 s[24:25], s[0:1], 80
  v_and_b32 v1, 63, v0
  v_lshrrev_b32 v17, 6, v0
  s_nop 0
  v_readfirstlane_b32 s44, v17
  s_mov_b32 s10, 2097152
  s_mov_b32 s11, 0x00020000
  s_mov_b32 s14, 1572864
  s_mov_b32 s15, 0x00020000
  s_mov_b32 s30, 16384
  s_mov_b32 s31, 0x00020000
  s_mov_b32 s38, 524288
  s_mov_b32 s39, 0x00020000
  s_mov_b32 s18, 1409024
  s_mov_b32 s19, 0x00020000
  s_mov_b32 s22, 1409024
  s_mov_b32 s23, 0x00020000
  s_mov_b32 s34, 1409024
  s_mov_b32 s35, 0x00020000
  s_mov_b32 s42, 2097152
  s_mov_b32 s43, 0x00020000
  s_mov_b32 s26, 9830400
  s_mov_b32 s27, 0x00020000
  s_and_b32 s49, s2, 7
  s_lshr_b32 s50, s2, 3
  s_and_b32 s51, s49, 1
  s_lshl_b32 s51, s51, 3
  s_lshr_b32 s52, s50, 2
  s_add_u32 s45, s51, s52
  s_lshr_b32 s51, s49, 1
  s_lshl_b32 s51, s51, 2
  s_and_b32 s52, s50, 3
  s_add_u32 s46, s51, s52
  s_lshl_b32 s51, s49, 2
  s_lshr_b32 s52, s50, 3
  s_add_u32 s55, s51, s52
  s_and_b32 s56, s50, 7
  s_lshr_b32 s69, s55, 1
  s_and_b32 s51, s46, 3
  s_lshl_b32 s51, s51, 1
  s_add_u32 s96, s45, s51
  s_bfe_u32 s51, s46, 0x10002
  s_add_u32 s96, s96, s51
  s_and_b32 s96, s96, 7
  s_mul_i32 s48, s44, 40960
  s_lshl_b32 s57, s45, 2
  s_add_u32 s57, s57, s44
  s_getpc_b64 s[72:73]
L_pc:
  s_sub_u32 s72, s72, L_pc-L_code0
  s_subb_u32 s73, s73, 0
  s_mov_b32 s74, L_end-L_code0
  s_mov_b32 s75, 0x00020000
  s_lshr_b32 s50, s2, 3
  s_mul_i32 s50, s50, 1152
  v_lshlrev_b32 v21, 7, v1
  v_cmp_gt_u32 vcc, 9, v1
  v_mov_b32 v22, 1073741824
  s_nop 0
  v_cndmask_b32 v22, v22, v21, vcc
  s_cmp_eq_u32 s44, 3
  s_cselect_b32 s50, s50, 1073741824
  buffer_load_dword a62, v22, s[72:75], s50 offen
  v_lshrrev_b32 v22, 3, v1
  v_lshrrev_b32 v23, 4, v1
  v_and_b32 v24, 7, v1
  v_or_b32 v21, 0, v23
  v_xor_b32 v21, v24, v21
  v_lshlrev_b32 v21, 4, v21
  v_lshl_add_u32 v17, v22, 10, v21
  v_or_b32 v21, 4, v23
  v_xor_b32 v21, v24, v21
  v_lshlrev_b32 v21, 4, v21
  v_lshl_add_u32 v18, v22, 10, v21
  v_add_u32 v19, 14336, v17
  v_add_u32 v20, 21504, v18
  v_add_u32 v18, 7168, v18
  s_lshl_b32 s99, s57, 15
  s_waitcnt lgkmcnt(0)
  s_add_u32 s97, s96, 0
  s_and_b32 s97, s97, 7
  s_lshl_b32 s97, s97, 7
  s_add_u32 s97, s97, s99
  s_add_u32 m0, s48, 0
  s_nop 0
  buffer_load_dwordx4 v17, s[8:11], s97 offen offset:0 lds
  buffer_load_dwordx4 v18, s[8:11], s97 offen offset:1024 lds
  buffer_load_dwordx4 v19, s[8:11], s97 offen offset:2048 lds
  buffer_load_dwordx4 v20, s[8:11], s97 offen offset:3072 lds
  s_add_u32 s97, s96, 1
  s_and_b32 s97, s97, 7
  s_lshl_b32 s97, s97, 7
  s_add_u32 s97, s97, s99
  s_add_u32 m0, s48, 4096
  s_nop 0
  buffer_load_dwordx4 v17, s[8:11], s97 offen offset:0 lds
  buffer_load_dwordx4 v18, s[8:11], s97 offen offset:1024 lds
  buffer_load_dwordx4 v19, s[8:11], s97 offen offset:2048 lds
  buffer_load_dwordx4 v20, s[8:11], s97 offen offset:3072 lds
  s_add_u32 s97, s96, 2
  s_and_b32 s97, s97, 7
  s_lshl_b32 s97, s97, 7
  s_add_u32 s97, s97, s99
  s_add_u32 m0, s48, 8192
  s_nop 0
  buffer_load_dwordx4 v17, s[8:11], s97 offen offset:0 lds
  buffer_load_dwordx4 v18, s[8:11], s97 offen offset:1024 lds
  buffer_load_dwordx4 v19, s[8:11], s97 offen offset:2048 lds
  buffer_load_dwordx4 v20, s[8:11], s97 offen offset:3072 lds
  buffer_load_dword v100, off, s[24:27], 0 sc1
  s_mul_i32 s51, s46, 3
  s_lshl_b32 s52, s46, 1
  s_add_u32 s52, s52, 11
  s_cmp_lt_u32 s46, 11
  s_cselect_b32 s53, s51, s52
  s_cselect_b32 s54, 3, 2
  s_mov_b32 s58, 0x3f803f80
  s_mov_b32 s64, 0x0000ffff
  s_mov_b32 s65, 0xffff0000
  s_mov_b32 s66, 0
  s_mov_b32 s67, -1
  v_and_b32 v21, 31, v1
  v_lshrrev_b32 v22, 5, v1
  v_bfe_u32 v23, v21, 1, 3
  v_xor_b32 v23, v22, v23
  v_lshlrev_b32 v24, 7, v21
  v_add_u32 v24, s48, v24
  v_xor_b32 v25, 0, v23
  v_lshl_add_u32 v48, v25, 4, v24
  v_xor_b32 v25, 2, v23
  v_lshl_add_u32 v49, v25, 4, v24
  v_xor_b32 v25, 4, v23
  v_lshl_add_u32 v50, v25, 4, v24
  v_xor_b32 v25, 6, v23
  v_lshl_add_u32 v51, v25, 4, v24
  v_mov_b32 v28, 0
  v_mov_b32 v29, 0
  v_mov_b32 v30, 0
  v_mov_b32 v31, 0
  s_lshl_b32 s52, s44, 4
  s_lshl_b32 s51, s53, 6
  s_add_u32 s49, s96, 0
  s_and_b32 s49, s49, 7
  s_lshl_b32 s49, s49, 6
  s_add_u32 s49, s49, s52
  s_mul_i32 s80, s49, 3072
  s_mul_i32 s50, s49, 2752
  s_add_u32 s88, s50, s51
  s_add_u32 s49, s96, 1
  s_and_b32 s49, s49, 7
  s_lshl_b32 s49, s49, 6
  s_add_u32 s49, s49, s52
  s_mul_i32 s81, s49, 3072
  s_mul_i32 s50, s49, 2752
  s_add_u32 s89, s50, s51
  s_add_u32 s49, s96, 2
  s_and_b32 s49, s49, 7
  s_lshl_b32 s49, s49, 6
  s_add_u32 s49, s49, s52
  s_mul_i32 s82, s49, 3072
  s_mul_i32 s50, s49, 2752
  s_add_u32 s90, s50, s51
  s_add_u32 s49, s96, 3
  s_and_b32 s49, s49, 7
  s_lshl_b32 s49, s49, 6
  s_add_u32 s49, s49, s52
  s_mul_i32 s83, s49, 3072
  s_mul_i32 s50, s49, 2752
  s_add_u32 s91, s50, s51
  s_add_u32 s49, s96, 4
  s_and_b32 s49, s49, 7
  s_lshl_b32 s49, s49, 6
  s_add_u32 s49, s49, s52
  s_mul_i32 s84, s49, 3072
  s_mul_i32 s50, s49, 2752
  s_add_u32 s92, s50, s51
  s_add_u32 s49, s96, 5
  s_and_b32 s49, s49, 7
  s_lshl_b32 s49, s49, 6
  s_add_u32 s49, s49, s52
  s_mul_i32 s85, s49, 3072
  s_mul_i32 s50, s49, 2752
  s_add_u32 s93, s50, s51
  s_add_u32 s49, s96, 6
  s_and_b32 s49, s49, 7
  s_lshl_b32 s49, s49, 6
  s_add_u32 s49, s49, s52
  s_mul_i32 s86, s49, 3072
  s_mul_i32 s50, s49, 2752
  s_add_u32 s94, s50, s51
  s_add_u32 s49, s96, 7
  s_and_b32 s49, s49, 7
  s_lshl_b32 s49, s49, 6
  s_add_u32 s49, s49, s52
  s_mul_i32 s87, s49, 3072
  s_mul_i32 s50, s49, 2752
  s_add_u32 s95, s50, s51
  s_lshl_b32 s49, s46, 6
  s_add_u32 s80, s80, s49
  s_add_u32 s81, s81, s49
  s_add_u32 s82, s82, s49
  s_add_u32 s83, s83, s49
  s_add_u32 s84, s84, s49
  s_add_u32 s85, s85, s49
  s_add_u32 s86, s86, s49
  s_add_u32 s87, s87, s49
  v_lshrrev_b32 v22, 2, v1
  v_and_b32 v23, 3, v1
  v_lshlrev_b32 v23, 4, v23
  s_mov_b32 s49, 3072
  v_mul_lo_u32 v21, v22, s49
  v_add_u32 v5, v21, v23
  s_mov_b32 s49, 43691
  s_mov_b32 s50, 2752
  s_lshl_b32 s3, s54, 6
  v_add_u32 v21, 0, v1
  v_mul_lo_u32 v22, v21, s49
  v_lshrrev_b32 v22, 19, v22
  v_mul_u32_u24 v23, 12, v22
  v_sub_u32 v23, v21, v23
  v_lshlrev_b32 v23, 4, v23
  v_mul_lo_u32 v22, v22, s50
  v_add_u32 v22, v22, v23
  v_subrev_u32 v6, 0, v22
  v_cmp_le_u32 s[6:7], s3, v23
  v_mov_b32 v22, 1073741824
  s_nop 0
  v_cndmask_b32 v6, v6, v22, s[6:7]
  v_add_u32 v21, 64, v1
  v_mul_lo_u32 v22, v21, s49
  v_lshrrev_b32 v22, 19, v22
  v_mul_u32_u24 v23, 12, v22
  v_sub_u32 v23, v21, v23
  v_lshlrev_b32 v23, 4, v23
  v_mul_lo_u32 v22, v22, s50
  v_add_u32 v22, v22, v23
  v_subrev_u32 v7, 1024, v22
  v_cmp_le_u32 s[6:7], s3, v23
  v_mov_b32 v22, 1073741824
  s_nop 0
  v_cndmask_b32 v7, v7, v22, s[6:7]
  v_add_u32 v21, 128, v1
  v_mul_lo_u32 v22, v21, s49
  v_lshrrev_b32 v22, 19, v22
  v_mul_u32_u24 v23, 12, v22
  v_sub_u32 v23, v21, v23
  v_lshlrev_b32 v23, 4, v23
  v_mul_lo_u32 v22, v22, s50
  v_add_u32 v22, v22, v23
  v_subrev_u32 v8, 2048, v22
  v_cmp_le_u32 s[6:7], s3, v23
  v_mov_b32 v22, 1073741824
  s_nop 0
  v_cndmask_b32 v8, v8, v22, s[6:7]
  v_and_b32 v21, 15, v1
  v_lshrrev_b32 v21, 2, v21
  v_lshrrev_b32 v22, 5, v1
  v_lshl_add_u32 v21, v22, 3, v21
  v_and_b32 v22, 3, v1
  v_lshlrev_b32 v22, 3, v22
  v_bfe_u32 v23, v1, 4, 1
  v_lshl_add_u32 v22, v23, 5, v22
  v_lshl_add_u32 v2, v21, 6, v22
  v_add_u32 v3, 65536, v2
  v_add_u32 v4, 131072, v2
  v_mul_u32_u24 v21, 192, v21
  v_add_u32 v9, v21, v22
  v_add_u32 v10, 65536, v9
  v_add_u32 v11, 131072, v9
  v_lshlrev_b32 v13, 4, v1
  v_and_b32 v21, 31, v1
  v_lshrrev_b32 v22, 5, v1
  v_bfe_u32 v23, v21, 2, 1
  v_and_b32 v24, 3, v21
  v_bfe_u32 v25, v21, 3, 1
  v_lshl_add_u32 v24, v25, 2, v24
  v_cmp_eq_u32 s[70:71], v23, v22
  v_cmp_gt_u32 s[72:73], 16, v21
  s_nop 3
  s_and_b64 s[74:75], s[70:71], s[72:73]
  s_andn2_b64 s[76:77], s[70:71], s[72:73]
  v_and_b32 v25, 1, v24
  v_lshlrev_b32 v25, 4, v25
  v_mov_b32 v26, 0x3f80
  v_lshlrev_b32 v25, v25, v26
  v_cndmask_b32 v25, 0, v25, s[74:75]
  v_lshrrev_b32 v26, 1, v24
  v_cmp_eq_u32 vcc, 0, v26
  s_nop 1
  v_cndmask_b32 v27, 0, v25, vcc
  v_accvgpr_write_b32 a32, v27
  v_cmp_eq_u32 vcc, 1, v26
  s_nop 1
  v_cndmask_b32 v27, 0, v25, vcc
  v_accvgpr_write_b32 a33, v27
  v_cmp_eq_u32 vcc, 2, v26
  s_nop 1
  v_cndmask_b32 v27, 0, v25, vcc
  v_accvgpr_write_b32 a34, v27
  s_waitcnt vmcnt(9)
  ds_read_b128 v[128:131], v48 offset:0
  ds_read_b128 v[132:135], v49 offset:0
  ds_read_b128 v[136:139], v50 offset:0
  ds_read_b128 v[140:143], v51 offset:0
  s_add_u32 s97, s96, 3
  s_and_b32 s97, s97, 7
  s_lshl_b32 s97, s97, 7
  s_add_u32 s97, s97, s99
  s_add_u32 m0, s48, 12288
  s_nop 0
  buffer_load_dwordx4 v17, s[8:11], s97 offen offset:0 lds
  buffer_load_dwordx4 v18, s[8:11], s97 offen offset:1024 lds
  buffer_load_dwordx4 v19, s[8:11], s97 offen offset:2048 lds
  buffer_load_dwordx4 v20, s[8:11], s97 offen offset:3072 lds
  v_cmp_eq_u32 vcc, 3, v26
  s_nop 1
  v_cndmask_b32 v27, 0, v25, vcc
  v_accvgpr_write_b32 a35, v27
  v_and_b32 v25, 1, v24
  v_lshlrev_b32 v25, 4, v25
  v_mov_b32 v26, 0x3f80
  s_waitcnt vmcnt(9)
  ds_read_b128 v[144:147], v48 offset:4096
  ds_read_b128 v[148:151], v49 offset:4096
  ds_read_b128 v[152:155], v50 offset:4096
  ds_read_b128 v[156:159], v51 offset:4096
  s_add_u32 s97, s96, 4
  s_and_b32 s97, s97, 7
  s_lshl_b32 s97, s97, 7
  s_add_u32 s97, s97, s99
  s_add_u32 m0, s48, 16384
  s_nop 0
  buffer_load_dwordx4 v17, s[8:11], s97 offen offset:0 lds
  buffer_load_dwordx4 v18, s[8:11], s97 offen offset:1024 lds
  buffer_load_dwordx4 v19, s[8:11], s97 offen offset:2048 lds
  buffer_load_dwordx4 v20, s[8:11], s97 offen offset:3072 lds
  s_waitcnt lgkmcnt(7)
  v_dot2c_f32_bf16 v29, s58, v128
  v_dot2c_f32_bf16 v31, v128, v128
  v_dot2c_f32_bf16 v28, s58, v129
  v_dot2c_f32_bf16 v30, v129, v129
  v_dot2c_f32_bf16 v29, s58, v130
  v_dot2c_f32_bf16 v31, v130, v130
  v_dot2c_f32_bf16 v28, s58, v131
  v_dot2c_f32_bf16 v30, v131, v131
  s_waitcnt lgkmcnt(6)
  v_dot2c_f32_bf16 v29, s58, v132
  v_dot2c_f32_bf16 v31, v132, v132
  v_dot2c_f32_bf16 v28, s58, v133
  v_dot2c_f32_bf16 v30, v133, v133
  v_dot2c_f32_bf16 v29, s58, v134
  v_dot2c_f32_bf16 v31, v134, v134
  v_dot2c_f32_bf16 v28, s58, v135
  v_dot2c_f32_bf16 v30, v135, v135
  s_waitcnt lgkmcnt(5)
  v_dot2c_f32_bf16 v29, s58, v136
  v_dot2c_f32_bf16 v31, v136, v136
  v_dot2c_f32_bf16 v28, s58, v137
  v_dot2c_f32_bf16 v30, v137, v137
  v_dot2c_f32_bf16 v29, s58, v138
  v_dot2c_f32_bf16 v31, v138, v138
  v_dot2c_f32_bf16 v28, s58, v139
  v_dot2c_f32_bf16 v30, v139, v139
  s_waitcnt lgkmcnt(4)
  v_dot2c_f32_bf16 v29, s58, v140
  v_dot2c_f32_bf16 v31, v140, v140
  v_dot2c_f32_bf16 v28, s58, v141
  v_dot2c_f32_bf16 v30, v141, v141
  v_dot2c_f32_bf16 v29, s58, v142
  v_dot2c_f32_bf16 v31, v142, v142
  v_dot2c_f32_bf16 v28, s58, v143
  v_dot2c_f32_bf16 v30, v143, v143
  v_lshlrev_b32 v25, v25, v26
  v_cndmask_b32 v25, 0, v25, s[76:77]
  v_lshrrev_b32 v26, 1, v24
  v_cmp_eq_u32 vcc, 0, v26
  s_nop 1
  v_cndmask_b32 v27, 0, v25, vcc
  v_accvgpr_write_b32 a36, v27
  s_waitcnt vmcnt(9)
  ds_read_b128 v[160:163], v48 offset:8192
  ds_read_b128 v[164:167], v49 offset:8192
  ds_read_b128 v[168:171], v50 offset:8192
  ds_read_b128 v[172:175], v51 offset:8192
  s_add_u32 s97, s96, 5
  s_and_b32 s97, s97, 7
  s_lshl_b32 s97, s97, 7
  s_add_u32 s97, s97, s99
  s_add_u32 m0, s48, 20480
  s_nop 0
  buffer_load_dwordx4 v17, s[8:11], s97 offen offset:0 lds
  buffer_load_dwordx4 v18, s[8:11], s97 offen offset:1024 lds
  buffer_load_dwordx4 v19, s[8:11], s97 offen offset:2048 lds
  buffer_load_dwordx4 v20, s[8:11], s97 offen offset:3072 lds
  s_waitcnt lgkmcnt(7)
  v_dot2c_f32_bf16 v29, s58, v144
  v_dot2c_f32_bf16 v31, v144, v144
  v_dot2c_f32_bf16 v28, s58, v145
  v_dot2c_f32_bf16 v30, v145, v145
  v_dot2c_f32_bf16 v29, s58, v146
  v_dot2c_f32_bf16 v31, v146, v146
  v_dot2c_f32_bf16 v28, s58, v147
  v_dot2c_f32_bf16 v30, v147, v147
  s_waitcnt lgkmcnt(6)
  v_dot2c_f32_bf16 v29, s58, v148
  v_dot2c_f32_bf16 v31, v148, v148
  v_dot2c_f32_bf16 v28, s58, v149
  v_dot2c_f32_bf16 v30, v149, v149
  v_dot2c_f32_bf16 v29, s58, v150
  v_dot2c_f32_bf16 v31, v150, v150
  v_dot2c_f32_bf16 v28, s58, v151
  v_dot2c_f32_bf16 v30, v151, v151
  s_waitcnt lgkmcnt(5)
  v_dot2c_f32_bf16 v29, s58, v152
  v_dot2c_f32_bf16 v31, v152, v152
  v_dot2c_f32_bf16 v28, s58, v153
  v_dot2c_f32_bf16 v30, v153, v153
  v_dot2c_f32_bf16 v29, s58, v154
  v_dot2c_f32_bf16 v31, v154, v154
  v_dot2c_f32_bf16 v28, s58, v155
  v_dot2c_f32_bf16 v30, v155, v155
  s_waitcnt lgkmcnt(4)
  v_dot2c_f32_bf16 v29, s58, v156
  v_dot2c_f32_bf16 v31, v156, v156
  v_dot2c_f32_bf16 v28, s58, v157
  v_dot2c_f32_bf16 v30, v157, v157
  v_dot2c_f32_bf16 v29, s58, v158
  v_dot2c_f32_bf16 v31, v158, v158
  v_dot2c_f32_bf16 v28, s58, v159
  v_dot2c_f32_bf16 v30, v159, v159
  v_cmp_eq_u32 vcc, 1, v26
  s_nop 1
  v_cndmask_b32 v27, 0, v25, vcc
  v_accvgpr_write_b32 a37, v27
  v_cmp_eq_u32 vcc, 2, v26
  s_nop 1
  v_cndmask_b32 v27, 0, v25, vcc
  v_accvgpr_write_b32 a38, v27
  s_waitcnt vmcnt(8)
  ds_read_b128 v[176:179], v48 offset:12288
  ds_read_b128 v[180:183], v49 offset:12288
  ds_read_b128 v[184:187], v50 offset:12288
  ds_read_b128 v[188:191], v51 offset:12288
  s_add_u32 s97, s96, 6
  s_and_b32 s97, s97, 7
  s_lshl_b32 s97, s97, 7
  s_add_u32 s97, s97, s99
  s_add_u32 m0, s48, 24576
  s_nop 0
  buffer_load_dwordx4 v17, s[8:11], s97 offen offset:0 lds
  buffer_load_dwordx4 v18, s[8:11], s97 offen offset:1024 lds
  buffer_load_dwordx4 v19, s[8:11], s97 offen offset:2048 lds
  buffer_load_dwordx4 v20, s[8:11], s97 offen offset:3072 lds
  s_waitcnt lgkmcnt(7)
  v_dot2c_f32_bf16 v29, s58, v160
  v_dot2c_f32_bf16 v31, v160, v160
  v_dot2c_f32_bf16 v28, s58, v161
  v_dot2c_f32_bf16 v30, v161, v161
  v_dot2c_f32_bf16 v29, s58, v162
  v_dot2c_f32_bf16 v31, v162, v162
  v_dot2c_f32_bf16 v28, s58, v163
  v_dot2c_f32_bf16 v30, v163, v163
  s_waitcnt lgkmcnt(6)
  v_dot2c_f32_bf16 v29, s58, v164
  v_dot2c_f32_bf16 v31, v164, v164
  v_dot2c_f32_bf16 v28, s58, v165
  v_dot2c_f32_bf16 v30, v165, v165
  v_dot2c_f32_bf16 v29, s58, v166
  v_dot2c_f32_bf16 v31, v166, v166
  v_dot2c_f32_bf16 v28, s58, v167
  v_dot2c_f32_bf16 v30, v167, v167
  s_waitcnt lgkmcnt(5)
  v_dot2c_f32_bf16 v29, s58, v168
  v_dot2c_f32_bf16 v31, v168, v168
  v_dot2c_f32_bf16 v28, s58, v169
  v_dot2c_f32_bf16 v30, v169, v169
  v_dot2c_f32_bf16 v29, s58, v170
  v_dot2c_f32_bf16 v31, v170, v170
  v_dot2c_f32_bf16 v28, s58, v171
  v_dot2c_f32_bf16 v30, v171, v171
  s_waitcnt lgkmcnt(4)
  v_dot2c_f32_bf16 v29, s58, v172
  v_dot2c_f32_bf16 v31, v172, v172
  v_dot2c_f32_bf16 v28, s58, v173
  v_dot2c_f32_bf16 v30, v173, v173
  v_dot2c_f32_bf16 v29, s58, v174
  v_dot2c_f32_bf16 v31, v174, v174
  v_dot2c_f32_bf16 v28, s58, v175
  v_dot2c_f32_bf16 v30, v175, v175
  v_cmp_eq_u32 vcc, 3, v26
  s_nop 1
  v_cndmask_b32 v27, 0, v25, vcc
  v_accvgpr_write_b32 a39, v27
  v_mov_b32 v25, s58
  v_cndmask_b32 v25, v25, 0, s[66:67]
  v_accvgpr_write_b32 a48, v25
  s_waitcnt vmcnt(8)
  ds_read_b128 v[192:195], v48 offset:16384
  ds_read_b128 v[196:199], v49 offset:16384
  ds_read_b128 v[200:203], v50 offset:16384
  ds_read_b128 v[204:207], v51 offset:16384
  s_add_u32 s97, s96, 7
  s_and_b32 s97, s97, 7
  s_lshl_b32 s97, s97, 7
  s_add_u32 s97, s97, s99
  s_add_u32 m0, s48, 28672
  s_nop 0
  buffer_load_dwordx4 v17, s[8:11], s97 offen offset:0 lds
  buffer_load_dwordx4 v18, s[8:11], s97 offen offset:1024 lds
  buffer_load_dwordx4 v19, s[8:11], s97 offen offset:2048 lds
  buffer_load_dwordx4 v20, s[8:11], s97 offen offset:3072 lds
  s_waitcnt lgkmcnt(7)
  v_dot2c_f32_bf16 v29, s58, v176
  v_dot2c_f32_bf16 v31, v176, v176
  v_dot2c_f32_bf16 v28, s58, v177
  v_dot2c_f32_bf16 v30, v177, v177
  v_dot2c_f32_bf16 v29, s58, v178
  v_dot2c_f32_bf16 v31, v178, v178
  v_dot2c_f32_bf16 v28, s58, v179
  v_dot2c_f32_bf16 v30, v179, v179
  s_waitcnt lgkmcnt(6)
  v_dot2c_f32_bf16 v29, s58, v180
  v_dot2c_f32_bf16 v31, v180, v180
  v_dot2c_f32_bf16 v28, s58, v181
  v_dot2c_f32_bf16 v30, v181, v181
  v_dot2c_f32_bf16 v29, s58, v182
  v_dot2c_f32_bf16 v31, v182, v182
  v_dot2c_f32_bf16 v28, s58, v183
  v_dot2c_f32_bf16 v30, v183, v183
  s_waitcnt lgkmcnt(5)
  v_dot2c_f32_bf16 v29, s58, v184
  v_dot2c_f32_bf16 v31, v184, v184
  v_dot2c_f32_bf16 v28, s58, v185
  v_dot2c_f32_bf16 v30, v185, v185
  v_dot2c_f32_bf16 v29, s58, v186
  v_dot2c_f32_bf16 v31, v186, v186
  v_dot2c_f32_bf16 v28, s58, v187
  v_dot2c_f32_bf16 v30, v187, v187
  s_waitcnt lgkmcnt(4)
  v_dot2c_f32_bf16 v29, s58, v188
  v_dot2c_f32_bf16 v31, v188, v188
  v_dot2c_f32_bf16 v28, s58, v189
  v_dot2c_f32_bf16 v30, v189, v189
  v_dot2c_f32_bf16 v29, s58, v190
  v_dot2c_f32_bf16 v31, v190, v190
  v_dot2c_f32_bf16 v28, s58, v191
  v_dot2c_f32_bf16 v30, v191, v191
  v_accvgpr_write_b32 a49, 0
  v_accvgpr_write_b32 a50, 0
  v_accvgpr_write_b32 a51, 0
  s_waitcnt vmcnt(8)
  ds_read_b128 v[208:211], v48 offset:20480
  ds_read_b128 v[212:215], v49 offset:20480
  ds_read_b128 v[216:219], v50 offset:20480
  ds_read_b128 v[220:223], v51 offset:20480
  s_add_u32 m0, s48, 32768
  s_add_u32 s98, s80, 1024
  buffer_load_dwordx4 v5, s[12:15], s98 offen lds
  s_add_u32 m0, s48, 33792
  s_add_u32 s98, s81, 1024
  buffer_load_dwordx4 v5, s[12:15], s98 offen lds
  s_add_u32 m0, s48, 34816
  s_add_u32 s98, s82, 1024
  buffer_load_dwordx4 v5, s[12:15], s98 offen lds
  s_waitcnt lgkmcnt(7)
  v_dot2c_f32_bf16 v29, s58, v192
  v_dot2c_f32_bf16 v31, v192, v192
  v_dot2c_f32_bf16 v28, s58, v193
  v_dot2c_f32_bf16 v30, v193, v193
  v_dot2c_f32_bf16 v29, s58, v194
  v_dot2c_f32_bf16 v31, v194, v194
  v_dot2c_f32_bf16 v28, s58, v195
  v_dot2c_f32_bf16 v30, v195, v195
  s_waitcnt lgkmcnt(6)
  v_dot2c_f32_bf16 v29, s58, v196
  v_dot2c_f32_bf16 v31, v196, v196
  v_dot2c_f32_bf16 v28, s58, v197
  v_dot2c_f32_bf16 v30, v197, v197
  v_dot2c_f32_bf16 v29, s58, v198
  v_dot2c_f32_bf16 v31, v198, v198
  v_dot2c_f32_bf16 v28, s58, v199
  v_dot2c_f32_bf16 v30, v199, v199
  s_waitcnt lgkmcnt(5)
  v_dot2c_f32_bf16 v29, s58, v200
  v_dot2c_f32_bf16 v31, v200, v200
  v_dot2c_f32_bf16 v28, s58, v201
  v_dot2c_f32_bf16 v30, v201, v201
  v_dot2c_f32_bf16 v29, s58, v202
  v_dot2c_f32_bf16 v31, v202, v202
  v_dot2c_f32_bf16 v28, s58, v203
  v_dot2c_f32_bf16 v30, v203, v203
  s_waitcnt lgkmcnt(4)
  v_dot2c_f32_bf16 v29, s58, v204
  v_dot2c_f32_bf16 v31, v204, v204
  v_dot2c_f32_bf16 v28, s58, v205
  v_dot2c_f32_bf16 v30, v205, v205
  v_dot2c_f32_bf16 v29, s58, v206
  v_dot2c_f32_bf16 v31, v206, v206
  v_dot2c_f32_bf16 v28, s58, v207
  v_dot2c_f32_bf16 v30, v207, v207
  s_waitcnt vmcnt(7)
  ds_read_b128 v[224:227], v48 offset:24576
  ds_read_b128 v[228:231], v49 offset:24576
  ds_read_b128 v[232:235], v50 offset:24576
  ds_read_b128 v[236:239], v51 offset:24576
  s_add_u32 m0, s48, 35840
  s_add_u32 s98, s83, 1024
  buffer_load_dwordx4 v5, s[12:15], s98 offen lds
  s_add_u32 m0, s48, 36864
  s_add_u32 s98, s84, 1024
  buffer_load_dwordx4 v5, s[12:15], s98 offen lds
  s_add_u32 m0, s48, 37888
  s_add_u32 s98, s85, 1024
  buffer_load_dwordx4 v5, s[12:15], s98 offen lds
  s_waitcnt lgkmcnt(7)
  v_dot2c_f32_bf16 v29, s58, v208
  v_dot2c_f32_bf16 v31, v208, v208
  v_dot2c_f32_bf16 v28, s58, v209
  v_dot2c_f32_bf16 v30, v209, v209
  v_dot2c_f32_bf16 v29, s58, v210
  v_dot2c_f32_bf16 v31, v210, v210
  v_dot2c_f32_bf16 v28, s58, v211
  v_dot2c_f32_bf16 v30, v211, v211
  s_waitcnt lgkmcnt(6)
  v_dot2c_f32_bf16 v29, s58, v212
  v_dot2c_f32_bf16 v31, v212, v212
  v_dot2c_f32_bf16 v28, s58, v213
  v_dot2c_f32_bf16 v30, v213, v213
  v_dot2c_f32_bf16 v29, s58, v214
  v_dot2c_f32_bf16 v31, v214, v214
  v_dot2c_f32_bf16 v28, s58, v215
  v_dot2c_f32_bf16 v30, v215, v215
  s_waitcnt lgkmcnt(5)
  v_dot2c_f32_bf16 v29, s58, v216
  v_dot2c_f32_bf16 v31, v216, v216
  v_dot2c_f32_bf16 v28, s58, v217
  v_dot2c_f32_bf16 v30, v217, v217
  v_dot2c_f32_bf16 v29, s58, v218
  v_dot2c_f32_bf16 v31, v218, v218
  v_dot2c_f32_bf16 v28, s58, v219
  v_dot2c_f32_bf16 v30, v219, v219
  s_waitcnt lgkmcnt(4)
  v_dot2c_f32_bf16 v29, s58, v220
  v_dot2c_f32_bf16 v31, v220, v220
  v_dot2c_f32_bf16 v28, s58, v221
  v_dot2c_f32_bf16 v30, v221, v221
  v_dot2c_f32_bf16 v29, s58, v222
  v_dot2c_f32_bf16 v31, v222, v222
  v_dot2c_f32_bf16 v28, s58, v223
  v_dot2c_f32_bf16 v30, v223, v223
  s_waitcnt vmcnt(6)
  ds_read_b128 v[240:243], v48 offset:28672
  ds_read_b128 v[244:247], v49 offset:28672
  ds_read_b128 v[248:251], v50 offset:28672
  ds_read_b128 v[252:255], v51 offset:28672
  s_add_u32 m0, s48, 38912
  s_add_u32 s98, s86, 1024
  buffer_load_dwordx4 v5, s[12:15], s98 offen lds
  s_add_u32 m0, s48, 39936
  s_add_u32 s98, s87, 1024
  buffer_load_dwordx4 v5, s[12:15], s98 offen lds
  s_waitcnt lgkmcnt(7)
  v_dot2c_f32_bf16 v29, s58, v224
  v_dot2c_f32_bf16 v31, v224, v224
  v_dot2c_f32_bf16 v28, s58, v225
  v_dot2c_f32_bf16 v30, v225, v225
  v_dot2c_f32_bf16 v29, s58, v226
  v_dot2c_f32_bf16 v31, v226, v226
  v_dot2c_f32_bf16 v28, s58, v227
  v_dot2c_f32_bf16 v30, v227, v227
  s_waitcnt lgkmcnt(6)
  v_dot2c_f32_bf16 v29, s58, v228
  v_dot2c_f32_bf16 v31, v228, v228
  v_dot2c_f32_bf16 v28, s58, v229
  v_dot2c_f32_bf16 v30, v229, v229
  v_dot2c_f32_bf16 v29, s58, v230
  v_dot2c_f32_bf16 v31, v230, v230
  v_dot2c_f32_bf16 v28, s58, v231
  v_dot2c_f32_bf16 v30, v231, v231
  s_waitcnt lgkmcnt(5)
  v_dot2c_f32_bf16 v29, s58, v232
  v_dot2c_f32_bf16 v31, v232, v232
  v_dot2c_f32_bf16 v28, s58, v233
  v_dot2c_f32_bf16 v30, v233, v233
  v_dot2c_f32_bf16 v29, s58, v234
  v_dot2c_f32_bf16 v31, v234, v234
  v_dot2c_f32_bf16 v28, s58, v235
  v_dot2c_f32_bf16 v30, v235, v235
  s_waitcnt lgkmcnt(4)
  v_dot2c_f32_bf16 v29, s58, v236
  v_dot2c_f32_bf16 v31, v236, v236
  v_dot2c_f32_bf16 v28, s58, v237
  v_dot2c_f32_bf16 v30, v237, v237
  v_dot2c_f32_bf16 v29, s58, v238
  v_dot2c_f32_bf16 v31, v238, v238
  v_dot2c_f32_bf16 v28, s58, v239
  v_dot2c_f32_bf16 v30, v239, v239
  s_waitcnt lgkmcnt(3)
  v_dot2c_f32_bf16 v29, s58, v240
  v_dot2c_f32_bf16 v31, v240, v240
  v_dot2c_f32_bf16 v28, s58, v241
  v_dot2c_f32_bf16 v30, v241, v241
  v_dot2c_f32_bf16 v29, s58, v242
  v_dot2c_f32_bf16 v31, v242, v242
  v_dot2c_f32_bf16 v28, s58, v243
  v_dot2c_f32_bf16 v30, v243, v243
  s_waitcnt lgkmcnt(2)
  v_dot2c_f32_bf16 v29, s58, v244
  v_dot2c_f32_bf16 v31, v244, v244
  v_dot2c_f32_bf16 v28, s58, v245
  v_dot2c_f32_bf16 v30, v245, v245
  v_dot2c_f32_bf16 v29, s58, v246
  v_dot2c_f32_bf16 v31, v246, v246
  v_dot2c_f32_bf16 v28, s58, v247
  v_dot2c_f32_bf16 v30, v247, v247
  s_waitcnt lgkmcnt(1)
  v_dot2c_f32_bf16 v29, s58, v248
  v_dot2c_f32_bf16 v31, v248, v248
  v_dot2c_f32_bf16 v28, s58, v249
  v_dot2c_f32_bf16 v30, v249, v249
  v_dot2c_f32_bf16 v29, s58, v250
  v_dot2c_f32_bf16 v31, v250, v250
  v_dot2c_f32_bf16 v28, s58, v251
  v_dot2c_f32_bf16 v30, v251, v251
  s_waitcnt lgkmcnt(0)
  v_dot2c_f32_bf16 v29, s58, v252
  v_dot2c_f32_bf16 v31, v252, v252
  v_dot2c_f32_bf16 v28, s58, v253
  v_dot2c_f32_bf16 v30, v253, v253
  v_dot2c_f32_bf16 v29, s58, v254
  v_dot2c_f32_bf16 v31, v254, v254
  v_dot2c_f32_bf16 v28, s58, v255
  v_dot2c_f32_bf16 v30, v255, v255
  v_readfirstlane_b32 s47, v100
  s_nop 3
  s_add_u32 s47, s47, 2654435769
  v_add_f32 v28, v28, v29
  v_add_f32 v30, v30, v31
  v_mov_b32 v29, v28
  v_mov_b32 v31, v30
  s_nop 0
  v_permlane32_swap_b32 v28, v29
  v_permlane32_swap_b32 v30, v31
  v_add_f32 v28, v28, v29
  v_add_f32 v30, v30, v31
  s_mov_b32 s49, 0x3b000000
  v_mul_f32 v28, s49, v28
  v_mul_f32 v30, s49, v30
  v_fma_f32 v30, -v28, v28, v30
  v_max_f32 v30, 0, v30
  v_add_f32 v30, 0x3727c5ac, v30
  v_rsq_f32 v15, v30
  v_sub_f32 v32, 0, v28
  v_sub_f32 v33, 0, v28
  v_sub_f32 v34, 0, v28
  v_sub_f32 v35, 0, v28
  v_sub_f32 v36, 0, v28
  v_sub_f32 v37, 0, v28
  v_sub_f32 v38, 0, v28
  v_sub_f32 v39, 0, v28
  v_sub_f32 v40, 0, v28
  v_sub_f32 v41, 0, v28
  v_sub_f32 v42, 0, v28
  v_sub_f32 v43, 0, v28
  v_sub_f32 v44, 0, v28
  v_sub_f32 v45, 0, v28
  v_sub_f32 v46, 0, v28
  v_sub_f32 v47, 0, v28
  v_mul_f32 v14, 0x3fb8aa3b, v15
  v_mul_f32 v16, v15, v15
  v_mfma_f32_32x32x16_bf16 v[48:63], a[32:35], v[128:131], v[32:47]
  v_mfma_f32_32x32x16_bf16 v[48:63], a[36:39], v[132:135], v[48:63]
  v_mfma_f32_32x32x16_bf16 v[64:79], a[32:35], v[136:139], v[32:47]
  v_mfma_f32_32x32x16_bf16 v[64:79], a[36:39], v[140:143], v[64:79]
  v_mfma_f32_32x32x16_bf16 v[80:95], a[32:35], v[144:147], v[32:47]
  s_nop 8
  v_cvt_pk_bf16_f32 v96, v48, v49
  v_cvt_pk_bf16_f32 v97, v50, v51
  v_cvt_pk_bf16_f32 v98, v52, v53
  v_cvt_pk_bf16_f32 v99, v54, v55
  v_cvt_pk_bf16_f32 v100, v56, v57
  v_cvt_pk_bf16_f32 v101, v58, v59
  v_cvt_pk_bf16_f32 v102, v60, v61
  v_cvt_pk_bf16_f32 v103, v62, v63
  v_mfma_f32_32x32x16_bf16 v[80:95], a[36:39], v[148:151], v[80:95]
  v_accvgpr_write_b32 a128, v96
  v_accvgpr_write_b32 a129, v97
  v_accvgpr_write_b32 a130, v98
  v_accvgpr_write_b32 a131, v99
  v_accvgpr_write_b32 a132, v100
  v_accvgpr_write_b32 a133, v101
  v_accvgpr_write_b32 a134, v102
  v_accvgpr_write_b32 a135, v103
  s_add_u32 m0, s48, 24576
  s_add_u32 s98, s80, 2048
  buffer_load_dwordx4 v5, s[12:15], s98 offen lds
  v_mfma_f32_32x32x16_bf16 v[48:63], a[32:35], v[152:155], v[32:47]
  v_cvt_pk_bf16_f32 v104, v64, v65
  v_cvt_pk_bf16_f32 v105, v66, v67
  v_cvt_pk_bf16_f32 v106, v68, v69
  v_cvt_pk_bf16_f32 v107, v70, v71
  v_cvt_pk_bf16_f32 v108, v72, v73
  v_cvt_pk_bf16_f32 v109, v74, v75
  v_cvt_pk_bf16_f32 v110, v76, v77
  v_cvt_pk_bf16_f32 v111, v78, v79
  v_mfma_f32_32x32x16_bf16 v[48:63], a[36:39], v[156:159], v[48:63]
  v_accvgpr_write_b32 a136, v104
  v_accvgpr_write_b32 a137, v105
  v_accvgpr_write_b32 a138, v106
  v_accvgpr_write_b32 a139, v107
  v_accvgpr_write_b32 a140, v108
  v_accvgpr_write_b32 a141, v109
  v_accvgpr_write_b32 a142, v110
  v_accvgpr_write_b32 a143, v111
  v_mfma_f32_32x32x16_bf16 v[64:79], a[32:35], v[160:163], v[32:47]
  v_cvt_pk_bf16_f32 v96, v80, v81
  v_cvt_pk_bf16_f32 v97, v82, v83
  v_cvt_pk_bf16_f32 v98, v84, v85
  v_cvt_pk_bf16_f32 v99, v86, v87
  v_cvt_pk_bf16_f32 v100, v88, v89
  v_cvt_pk_bf16_f32 v101, v90, v91
  v_cvt_pk_bf16_f32 v102, v92, v93
  v_cvt_pk_bf16_f32 v103, v94, v95
  v_mfma_f32_32x32x16_bf16 v[64:79], a[36:39], v[164:167], v[64:79]
  v_accvgpr_write_b32 a144, v96
  v_accvgpr_write_b32 a145, v97
  v_accvgpr_write_b32 a146, v98
  v_accvgpr_write_b32 a147, v99
  v_accvgpr_write_b32 a148, v100
  v_accvgpr_write_b32 a149, v101
  v_accvgpr_write_b32 a150, v102
  v_accvgpr_write_b32 a151, v103
  s_add_u32 m0, s48, 25600
  s_add_u32 s98, s81, 2048
  buffer_load_dwordx4 v5, s[12:15], s98 offen lds
  v_mfma_f32_32x32x16_bf16 v[80:95], a[32:35], v[168:171], v[32:47]
  v_cvt_pk_bf16_f32 v104, v48, v49
  v_cvt_pk_bf16_f32 v105, v50, v51
  v_cvt_pk_bf16_f32 v106, v52, v53
  v_cvt_pk_bf16_f32 v107, v54, v55
  v_cvt_pk_bf16_f32 v108, v56, v57
  v_cvt_pk_bf16_f32 v109, v58, v59
  v_cvt_pk_bf16_f32 v110, v60, v61
  v_cvt_pk_bf16_f32 v111, v62, v63
  v_mfma_f32_32x32x16_bf16 v[80:95], a[36:39], v[172:175], v[80:95]
  v_accvgpr_write_b32 a152, v104
  v_accvgpr_write_b32 a153, v105
  v_accvgpr_write_b32 a154, v106
  v_accvgpr_write_b32 a155, v107
  v_accvgpr_write_b32 a156, v108
  v_accvgpr_write_b32 a157, v109
  v_accvgpr_write_b32 a158, v110
  v_accvgpr_write_b32 a159, v111
  v_mfma_f32_32x32x16_bf16 v[48:63], a[32:35], v[176:179], v[32:47]
  v_cvt_pk_bf16_f32 v96, v64, v65
  v_cvt_pk_bf16_f32 v97, v66, v67
  v_cvt_pk_bf16_f32 v98, v68, v69
  v_cvt_pk_bf16_f32 v99, v70, v71
  v_cvt_pk_bf16_f32 v100, v72, v73
  v_cvt_pk_bf16_f32 v101, v74, v75
  v_cvt_pk_bf16_f32 v102, v76, v77
  v_cvt_pk_bf16_f32 v103, v78, v79
  v_mfma_f32_32x32x16_bf16 v[48:63], a[36:39], v[180:183], v[48:63]
  v_accvgpr_write_b32 a160, v96
  v_accvgpr_write_b32 a161, v97
  v_accvgpr_write_b32 a162, v98
  v_accvgpr_write_b32 a163, v99
  v_accvgpr_write_b32 a164, v100
  v_accvgpr_write_b32 a165, v101
  v_accvgpr_write_b32 a166, v102
  v_accvgpr_write_b32 a167, v103
  s_add_u32 m0, s48, 26624
  s_add_u32 s98, s82, 2048
  buffer_load_dwordx4 v5, s[12:15], s98 offen lds
  v_mfma_f32_32x32x16_bf16 v[64:79], a[32:35], v[184:187], v[32:47]
  v_cvt_pk_bf16_f32 v104, v80, v81
  v_cvt_pk_bf16_f32 v105, v82, v83
  v_cvt_pk_bf16_f32 v106, v84, v85
  v_cvt_pk_bf16_f32 v107, v86, v87
  v_cvt_pk_bf16_f32 v108, v88, v89
  v_cvt_pk_bf16_f32 v109, v90, v91
  v_cvt_pk_bf16_f32 v110, v92, v93
  v_cvt_pk_bf16_f32 v111, v94, v95
  v_mfma_f32_32x32x16_bf16 v[64:79], a[36:39], v[188:191], v[64:79]
  v_accvgpr_write_b32 a168, v104
  v_accvgpr_write_b32 a169, v105
  v_accvgpr_write_b32 a170, v106
  v_accvgpr_write_b32 a171, v107
  v_accvgpr_write_b32 a172, v108
  v_accvgpr_write_b32 a173, v109
  v_accvgpr_write_b32 a174, v110
  v_accvgpr_write_b32 a175, v111
  v_mfma_f32_32x32x16_bf16 v[80:95], a[32:35], v[192:195], v[32:47]
  v_cvt_pk_bf16_f32 v96, v48, v49
  v_cvt_pk_bf16_f32 v97, v50, v51
  v_cvt_pk_bf16_f32 v98, v52, v53
  v_cvt_pk_bf16_f32 v99, v54, v55
  v_cvt_pk_bf16_f32 v100, v56, v57
  v_cvt_pk_bf16_f32 v101, v58, v59
  v_cvt_pk_bf16_f32 v102, v60, v61
  v_cvt_pk_bf16_f32 v103, v62, v63
  v_mfma_f32_32x32x16_bf16 v[80:95], a[36:39], v[196:199], v[80:95]
  v_accvgpr_write_b32 a176, v96
  v_accvgpr_write_b32 a177, v97
  v_accvgpr_write_b32 a178, v98
  v_accvgpr_write_b32 a179, v99
  v_accvgpr_write_b32 a180, v100
  v_accvgpr_write_b32 a181, v101
  v_accvgpr_write_b32 a182, v102
  v_accvgpr_write_b32 a183, v103
  s_add_u32 m0, s48, 27648
  s_add_u32 s98, s83, 2048
  buffer_load_dwordx4 v5, s[12:15], s98 offen lds
  v_mfma_f32_32x32x16_bf16 v[48:63], a[32:35], v[200:203], v[32:47]
  v_cvt_pk_bf16_f32 v104, v64, v65
  v_cvt_pk_bf16_f32 v105, v66, v67
  v_cvt_pk_bf16_f32 v106, v68, v69
  v_cvt_pk_bf16_f32 v107, v70, v71
  v_cvt_pk_bf16_f32 v108, v72, v73
  v_cvt_pk_bf16_f32 v109, v74, v75
  v_cvt_pk_bf16_f32 v110, v76, v77
  v_cvt_pk_bf16_f32 v111, v78, v79
  v_mfma_f32_32x32x16_bf16 v[48:63], a[36:39], v[204:207], v[48:63]
  v_accvgpr_write_b32 a184, v104
  v_accvgpr_write_b32 a185, v105
  v_accvgpr_write_b32 a186, v106
  v_accvgpr_write_b32 a187, v107
  v_accvgpr_write_b32 a188, v108
  v_accvgpr_write_b32 a189, v109
  v_accvgpr_write_b32 a190, v110
  v_accvgpr_write_b32 a191, v111
  v_mfma_f32_32x32x16_bf16 v[64:79], a[32:35], v[208:211], v[32:47]
  v_cvt_pk_bf16_f32 v96, v80, v81
  v_cvt_pk_bf16_f32 v97, v82, v83
  v_cvt_pk_bf16_f32 v98, v84, v85
  v_cvt_pk_bf16_f32 v99, v86, v87
  v_cvt_pk_bf16_f32 v100, v88, v89
  v_cvt_pk_bf16_f32 v101, v90, v91
  v_cvt_pk_bf16_f32 v102, v92, v93
  v_cvt_pk_bf16_f32 v103, v94, v95
  v_mfma_f32_32x32x16_bf16 v[64:79], a[36:39], v[212:215], v[64:79]
  v_accvgpr_write_b32 a192, v96
  v_accvgpr_write_b32 a193, v97
  v_accvgpr_write_b32 a194, v98
  v_accvgpr_write_b32 a195, v99
  v_accvgpr_write_b32 a196, v100
  v_accvgpr_write_b32 a197, v101
  v_accvgpr_write_b32 a198, v102
  v_accvgpr_write_b32 a199, v103
  s_add_u32 m0, s48, 28672
  s_add_u32 s98, s84, 2048
  buffer_load_dwordx4 v5, s[12:15], s98 offen lds
  v_mfma_f32_32x32x16_bf16 v[80:95], a[32:35], v[216:219], v[32:47]
  v_cvt_pk_bf16_f32 v104, v48, v49
  v_cvt_pk_bf16_f32 v105, v50, v51
  v_cvt_pk_bf16_f32 v106, v52, v53
  v_cvt_pk_bf16_f32 v107, v54, v55
  v_cvt_pk_bf16_f32 v108, v56, v57
  v_cvt_pk_bf16_f32 v109, v58, v59
  v_cvt_pk_bf16_f32 v110, v60, v61
  v_cvt_pk_bf16_f32 v111, v62, v63
  v_mfma_f32_32x32x16_bf16 v[80:95], a[36:39], v[220:223], v[80:95]
  v_accvgpr_write_b32 a200, v104
  v_accvgpr_write_b32 a201, v105
  v_accvgpr_write_b32 a202, v106
  v_accvgpr_write_b32 a203, v107
  v_accvgpr_write_b32 a204, v108
  v_accvgpr_write_b32 a205, v109
  v_accvgpr_write_b32 a206, v110
  v_accvgpr_write_b32 a207, v111
  v_mfma_f32_32x32x16_bf16 v[48:63], a[32:35], v[224:227], v[32:47]
  v_cvt_pk_bf16_f32 v96, v64, v65
  v_cvt_pk_bf16_f32 v97, v66, v67
  v_cvt_pk_bf16_f32 v98, v68, v69
  v_cvt_pk_bf16_f32 v99, v70, v71
  v_cvt_pk_bf16_f32 v100, v72, v73
  v_cvt_pk_bf16_f32 v101, v74, v75
  v_cvt_pk_bf16_f32 v102, v76, v77
  v_cvt_pk_bf16_f32 v103, v78, v79
  v_mfma_f32_32x32x16_bf16 v[48:63], a[36:39], v[228:231], v[48:63]
  v_accvgpr_write_b32 a208, v96
  v_accvgpr_write_b32 a209, v97
  v_accvgpr_write_b32 a210, v98
  v_accvgpr_write_b32 a211, v99
  v_accvgpr_write_b32 a212, v100
  v_accvgpr_write_b32 a213, v101
  v_accvgpr_write_b32 a214, v102
  v_accvgpr_write_b32 a215, v103
  s_add_u32 m0, s48, 29696
  s_add_u32 s98, s85, 2048
  buffer_load_dwordx4 v5, s[12:15], s98 offen lds
  v_mfma_f32_32x32x16_bf16 v[64:79], a[32:35], v[232:235], v[32:47]
  v_cvt_pk_bf16_f32 v104, v80, v81
  v_cvt_pk_bf16_f32 v105, v82, v83
  v_cvt_pk_bf16_f32 v106, v84, v85
  v_cvt_pk_bf16_f32 v107, v86, v87
  v_cvt_pk_bf16_f32 v108, v88, v89
  v_cvt_pk_bf16_f32 v109, v90, v91
  v_cvt_pk_bf16_f32 v110, v92, v93
  v_cvt_pk_bf16_f32 v111, v94, v95
  v_mfma_f32_32x32x16_bf16 v[64:79], a[36:39], v[236:239], v[64:79]
  v_accvgpr_write_b32 a216, v104
  v_accvgpr_write_b32 a217, v105
  v_accvgpr_write_b32 a218, v106
  v_accvgpr_write_b32 a219, v107
  v_accvgpr_write_b32 a220, v108
  v_accvgpr_write_b32 a221, v109
  v_accvgpr_write_b32 a222, v110
  v_accvgpr_write_b32 a223, v111
  v_mfma_f32_32x32x16_bf16 v[80:95], a[32:35], v[240:243], v[32:47]
  v_cvt_pk_bf16_f32 v96, v48, v49
  v_cvt_pk_bf16_f32 v97, v50, v51
  v_cvt_pk_bf16_f32 v98, v52, v53
  v_cvt_pk_bf16_f32 v99, v54, v55
  v_cvt_pk_bf16_f32 v100, v56, v57
  v_cvt_pk_bf16_f32 v101, v58, v59
  v_cvt_pk_bf16_f32 v102, v60, v61
  v_cvt_pk_bf16_f32 v103, v62, v63
  v_mfma_f32_32x32x16_bf16 v[80:95], a[36:39], v[244:247], v[80:95]
  v_accvgpr_write_b32 a224, v96
  v_accvgpr_write_b32 a225, v97
  v_accvgpr_write_b32 a226, v98
  v_accvgpr_write_b32 a227, v99
  v_accvgpr_write_b32 a228, v100
  v_accvgpr_write_b32 a229, v101
  v_accvgpr_write_b32 a230, v102
  v_accvgpr_write_b32 a231, v103
  s_add_u32 m0, s48, 30720
  s_add_u32 s98, s86, 2048
  buffer_load_dwordx4 v5, s[12:15], s98 offen lds
  v_mfma_f32_32x32x16_bf16 v[48:63], a[32:35], v[248:251], v[32:47]
  v_cvt_pk_bf16_f32 v104, v64, v65
  v_cvt_pk_bf16_f32 v105, v66, v67
  v_cvt_pk_bf16_f32 v106, v68, v69
  v_cvt_pk_bf16_f32 v107, v70, v71
  v_cvt_pk_bf16_f32 v108, v72, v73
  v_cvt_pk_bf16_f32 v109, v74, v75
  v_cvt_pk_bf16_f32 v110, v76, v77
  v_cvt_pk_bf16_f32 v111, v78, v79
  v_mfma_f32_32x32x16_bf16 v[48:63], a[36:39], v[252:255], v[48:63]
  v_accvgpr_write_b32 a232, v104
  v_accvgpr_write_b32 a233, v105
  v_accvgpr_write_b32 a234, v106
  v_accvgpr_write_b32 a235, v107
  v_accvgpr_write_b32 a236, v108
  v_accvgpr_write_b32 a237, v109
  v_accvgpr_write_b32 a238, v110
  v_accvgpr_write_b32 a239, v111
  v_cvt_pk_bf16_f32 v96, v80, v81
  v_cvt_pk_bf16_f32 v97, v82, v83
  v_cvt_pk_bf16_f32 v98, v84, v85
  v_cvt_pk_bf16_f32 v99, v86, v87
  v_cvt_pk_bf16_f32 v100, v88, v89
  v_cvt_pk_bf16_f32 v101, v90, v91
  v_cvt_pk_bf16_f32 v102, v92, v93
  v_cvt_pk_bf16_f32 v103, v94, v95
  v_accvgpr_write_b32 a240, v96
  v_accvgpr_write_b32 a241, v97
  v_accvgpr_write_b32 a242, v98
  v_accvgpr_write_b32 a243, v99
  v_accvgpr_write_b32 a244, v100
  v_accvgpr_write_b32 a245, v101
  v_accvgpr_write_b32 a246, v102
  v_accvgpr_write_b32 a247, v103
  s_add_u32 m0, s48, 31744
  s_add_u32 s98, s87, 2048
  buffer_load_dwordx4 v5, s[12:15], s98 offen lds
  v_cvt_pk_bf16_f32 v104, v48, v49
  v_cvt_pk_bf16_f32 v105, v50, v51
  v_cvt_pk_bf16_f32 v106, v52, v53
  v_cvt_pk_bf16_f32 v107, v54, v55
  v_cvt_pk_bf16_f32 v108, v56, v57
  v_cvt_pk_bf16_f32 v109, v58, v59
  v_cvt_pk_bf16_f32 v110, v60, v61
  v_cvt_pk_bf16_f32 v111, v62, v63
  v_accvgpr_write_b32 a248, v104
  v_accvgpr_write_b32 a249, v105
  v_accvgpr_write_b32 a250, v106
  v_accvgpr_write_b32 a251, v107
  v_accvgpr_write_b32 a252, v108
  v_accvgpr_write_b32 a253, v109
  v_accvgpr_write_b32 a254, v110
  v_accvgpr_write_b32 a255, v111
  v_and_b32 v21, 31, v1
  v_lshrrev_b32 v22, 5, v1
  v_bfe_u32 v23, v21, 2, 1
  v_and_b32 v24, 3, v21
  v_lshrrev_b32 v25, 3, v21
  v_lshl_add_u32 v24, v25, 2, v24
  v_lshlrev_b32 v24, 1, v24
  v_lshl_add_u32 v24, v22, 7, v24
  v_lshl_add_u32 v24, v23, 9, v24
  s_lshl_b32 s49, s46, 10
  buffer_load_ushort v112, v24, s[28:31], s49 offen offset:0
  buffer_load_ushort v113, v24, s[28:31], s49 offen offset:32
  buffer_load_ushort v114, v24, s[28:31], s49 offen offset:64
  buffer_load_ushort v115, v24, s[28:31], s49 offen offset:96
  buffer_load_ushort v116, v24, s[28:31], s49 offen offset:256
  buffer_load_ushort v117, v24, s[28:31], s49 offen offset:288
  buffer_load_ushort v118, v24, s[28:31], s49 offen offset:320
  buffer_load_ushort v119, v24, s[28:31], s49 offen offset:352
  v_cmp_eq_u32 s[70:71], 0, v23
  s_waitcnt vmcnt(16)
  s_barrier
  ds_read_b64_tr_b16 a[0:1], v2 offset:32768
  ds_read_b64_tr_b16 a[2:3], v2 offset:33024
  ds_read_b64_tr_b16 a[4:5], v3 offset:8192
  ds_read_b64_tr_b16 a[6:7], v3 offset:8448
  ds_read_b64_tr_b16 a[8:9], v3 offset:49152
  ds_read_b64_tr_b16 a[10:11], v3 offset:49408
  ds_read_b64_tr_b16 a[12:13], v4 offset:24576
  ds_read_b64_tr_b16 a[14:15], v4 offset:24832
  s_waitcnt lgkmcnt(4)
  v_mfma_f32_32x32x16_bf16 v[32:47], a[0:3], a[128:131], 0
  s_add_u32 m0, s48, 0
  ds_read_b64_tr_b16 a[16:17], v2 offset:33792
  ds_read_b64_tr_b16 a[18:19], v2 offset:34048
  buffer_load_dwordx4 v6, s[16:19], s88 offen offset:0 lds
  v_mfma_f32_32x32x16_bf16 v[32:47], a[4:7], a[132:135], v[32:47]
  ds_read_b64_tr_b16 a[20:21], v3 offset:9216
  ds_read_b64_tr_b16 a[22:23], v3 offset:9472
  s_waitcnt vmcnt(7)
  v_lshl_or_b32 v112, v113, 16, v112
  v_cndmask_b32 v25, 0, v112, s[70:71]
  v_cndmask_b32 v26, v112, 0, s[70:71]
  v_accvgpr_write_b32 a40, v25
  v_accvgpr_write_b32 a44, v26
  s_waitcnt vmcnt(5)
  v_lshl_or_b32 v114, v115, 16, v114
  s_waitcnt lgkmcnt(4)
  v_mfma_f32_32x32x16_bf16 v[32:47], a[8:11], a[136:139], v[32:47]
  ds_read_b64_tr_b16 a[0:1], v3 offset:50176
  ds_read_b64_tr_b16 a[2:3], v3 offset:50432
  v_cndmask_b32 v25, 0, v114, s[70:71]
  v_cndmask_b32 v26, v114, 0, s[70:71]
  v_accvgpr_write_b32 a41, v25
  v_accvgpr_write_b32 a45, v26
  s_waitcnt vmcnt(3)
  v_lshl_or_b32 v116, v117, 16, v116
  v_mfma_f32_32x32x16_bf16 v[32:47], a[12:15], a[140:143], v[32:47]
  s_add_u32 m0, s48, 0
  ds_read_b64_tr_b16 a[4:5], v4 offset:25600
  ds_read_b64_tr_b16 a[6:7], v4 offset:25856
  buffer_load_dwordx4 v7, s[16:19], s88 offen offset:1024 lds
  v_cndmask_b32 v25, 0, v116, s[70:71]
  v_cndmask_b32 v26, v116, 0, s[70:71]
  v_accvgpr_write_b32 a42, v25
  v_accvgpr_write_b32 a46, v26
  s_waitcnt vmcnt(2)
  v_lshl_or_b32 v118, v119, 16, v118
  s_waitcnt lgkmcnt(4)
  v_mfma_f32_32x32x16_bf16 v[32:47], a[16:19], a[144:147], v[32:47]
  ds_read_b64_tr_b16 a[8:9], v2 offset:34816
  ds_read_b64_tr_b16 a[10:11], v2 offset:35072
  v_cndmask_b32 v25, 0, v118, s[70:71]
  v_cndmask_b32 v26, v118, 0, s[70:71]
  v_accvgpr_write_b32 a43, v25
  v_accvgpr_write_b32 a47, v26
  s_lshr_b32 s49, s44, 1
  v_mfma_f32_32x32x16_bf16 v[32:47], a[20:23], a[148:151], v[32:47]
  ds_read_b64_tr_b16 a[12:13], v3 offset:10240
  ds_read_b64_tr_b16 a[14:15], v3 offset:10496
  s_and_b32 s50, s44, 1
  s_lshl_b32 s51, s55, 1
  s_add_u32 s51, s51, s50
  s_mul_i32 s52, s49, 43
  s_mul_i32 s59, s51, 86
  s_add_u32 s59, s59, s52
  s_waitcnt lgkmcnt(4)
  v_mfma_f32_32x32x16_bf16 v[32:47], a[0:3], a[152:155], v[32:47]
  s_add_u32 m0, s48, 0
  ds_read_b64_tr_b16 a[16:17], v3 offset:51200
  ds_read_b64_tr_b16 a[18:19], v3 offset:51456
  buffer_load_dwordx4 v8, s[16:19], s88 offen offset:2048 lds
  s_lshl_b32 s59, s59, 10
  s_add_u32 s59, s59, 4194304
  s_lshl_b32 s60, s51, 5
  v_mfma_f32_32x32x16_bf16 v[32:47], a[4:7], a[156:159], v[32:47]
  ds_read_b64_tr_b16 a[20:21], v4 offset:26624
  ds_read_b64_tr_b16 a[22:23], v4 offset:26880
  s_lshl_b32 s97, s49, 4
  s_add_u32 s60, s60, s97
  s_lshl_b32 s60, s60, 10
  s_add_u32 s60, s60, 2097152
  s_lshl_b32 s61, s56, 7
  s_lshl_b32 s98, s50, 13
  s_add_u32 s61, s61, s98
  s_waitcnt lgkmcnt(4)
  v_mfma_f32_32x32x16_bf16 v[32:47], a[8:11], a[160:163], v[32:47]
  ds_read_b64_tr_b16 a[0:1], v2 offset:35840
  ds_read_b64_tr_b16 a[2:3], v2 offset:36096
  s_lshl_b32 s97, s97, 14
  s_add_u32 s62, s61, s97
  s_lshl_b32 s52, s52, 14
  s_add_u32 s61, s61, s52
  s_mul_i32 s63, s49, 81920
  v_mfma_f32_32x32x16_bf16 v[32:47], a[12:15], a[164:167], v[32:47]
  s_add_u32 m0, s48, 3072
  ds_read_b64_tr_b16 a[4:5], v3 offset:11264
  ds_read_b64_tr_b16 a[6:7], v3 offset:11520
  buffer_load_dwordx4 v6, s[20:23], s88 offen offset:0 lds
  s_lshl_b32 s99, s51, 15
  s_lshl_b32 s97, s56, 7
  s_add_u32 s99, s99, s97
  s_lshl_b32 s97, s49, 6
  s_waitcnt lgkmcnt(4)
  v_mfma_f32_32x32x16_bf16 v[32:47], a[16:19], a[168:171], v[32:47]
  ds_read_b64_tr_b16 a[8:9], v3 offset:52224
  ds_read_b64_tr_b16 a[10:11], v3 offset:52480
  s_add_u32 s99, s99, s97
  v_lshrrev_b32 v17, 3, v1
  v_bfe_u32 v18, v17, 1, 1
  v_lshlrev_b32 v18, 2, v18
  v_and_b32 v19, 7, v1
  v_mfma_f32_32x32x16_bf16 v[32:47], a[20:23], a[172:175], v[32:47]
  ds_read_b64_tr_b16 a[12:13], v4 offset:27648
  ds_read_b64_tr_b16 a[14:15], v4 offset:27904
  v_xor_b32 v18, v18, v19
  v_lshlrev_b32 v18, 4, v18
  v_lshl_add_u32 v12, v17, 10, v18
  v_add_u32 v227, 16384, v12
  v_add_u32 v228, 32768, v12
  v_add_u32 v229, 49152, v12
  s_waitcnt lgkmcnt(4)
  v_mfma_f32_32x32x16_bf16 v[32:47], a[0:3], a[176:179], v[32:47]
  ds_read_b64_tr_b16 a[16:17], v2 offset:36864
  ds_read_b64_tr_b16 a[18:19], v2 offset:37120
  s_lshl_b32 s50, s50, 10
  s_add_u32 s63, s63, s50
  v_and_b32 v17, 31, v1
  v_lshlrev_b32 v17, 10, v17
  v_lshrrev_b32 v18, 5, v1
  v_mfma_f32_32x32x16_bf16 v[32:47], a[4:7], a[180:183], v[32:47]
  s_add_u32 m0, s48, 3072
  ds_read_b64_tr_b16 a[20:21], v3 offset:12288
  ds_read_b64_tr_b16 a[22:23], v3 offset:12544
  buffer_load_dwordx4 v7, s[20:23], s88 offen offset:1024 lds
  v_lshl_add_u32 v230, v18, 3, v17
  s_and_b32 s49, s55, 3
  s_mul_i32 s49, s49, 3
  s_add_u32 s49, s49, s56
  s_waitcnt lgkmcnt(4)
  v_mfma_f32_32x32x16_bf16 v[32:47], a[8:11], a[184:187], v[32:47]
  ds_read_b64_tr_b16 a[0:1], v3 offset:53248
  ds_read_b64_tr_b16 a[2:3], v3 offset:53504
  s_lshr_b32 s50, s55, 2
  s_add_u32 s49, s49, s50
  s_cmp_ge_u32 s49, 11
  s_cselect_b32 s50, 11, 0
  s_sub_u32 s49, s49, s50
  v_mfma_f32_32x32x16_bf16 v[32:47], a[12:15], a[188:191], v[32:47]
  ds_read_b64_tr_b16 a[4:5], v4 offset:28672
  ds_read_b64_tr_b16 a[6:7], v4 offset:28928
  s_cmp_ge_u32 s49, 11
  s_cselect_b32 s50, 11, 0
  s_sub_u32 s49, s49, s50
  s_lshl_b32 s28, s49, 12
  s_add_u32 s49, s49, 1
  s_cmp_eq_u32 s49, 11
  s_cselect_b32 s49, 0, s49
  s_waitcnt lgkmcnt(4)
  v_mfma_f32_32x32x16_bf16 v[32:47], a[16:19], a[192:195], v[32:47]
  s_add_u32 m0, s48, 3072
  ds_read_b64_tr_b16 a[8:9], v2 offset:37888
  ds_read_b64_tr_b16 a[10:11], v2 offset:38144
  buffer_load_dwordx4 v8, s[20:23], s88 offen offset:2048 lds
  s_lshl_b32 s29, s49, 12
  s_add_u32 s49, s49, 1
  v_mfma_f32_32x32x16_bf16 v[32:47], a[20:23], a[196:199], v[32:47]
  ds_read_b64_tr_b16 a[12:13], v3 offset:13312
  ds_read_b64_tr_b16 a[14:15], v3 offset:13568
  s_cmp_eq_u32 s49, 11
  s_cselect_b32 s49, 0, s49
  s_lshl_b32 s30, s49, 12
  s_add_u32 s49, s49, 1
  s_cmp_eq_u32 s49, 11
  s_cselect_b32 s49, 0, s49
  s_waitcnt lgkmcnt(4)
  v_mfma_f32_32x32x16_bf16 v[32:47], a[0:3], a[200:203], v[32:47]
  ds_read_b64_tr_b16 a[16:17], v3 offset:54272
  ds_read_b64_tr_b16 a[18:19], v3 offset:54528
  s_lshl_b32 s31, s49, 12
  s_add_u32 s49, s49, 1
  s_cmp_eq_u32 s49, 11
  s_cselect_b32 s49, 0, s49
  s_lshl_b32 s70, s49, 12
  v_mfma_f32_32x32x16_bf16 v[32:47], a[4:7], a[204:207], v[32:47]
  s_add_u32 m0, s48, 6144
  ds_read_b64_tr_b16 a[20:21], v4 offset:29696
  ds_read_b64_tr_b16 a[22:23], v4 offset:29952
  buffer_load_dwordx4 v6, s[16:19], s89 offen offset:0 lds
  s_add_u32 s49, s49, 1
  s_cmp_eq_u32 s49, 11
  s_cselect_b32 s49, 0, s49
  s_lshl_b32 s71, s49, 12
  s_waitcnt lgkmcnt(4)
  v_mfma_f32_32x32x16_bf16 v[32:47], a[8:11], a[208:211], v[32:47]
  ds_read_b64_tr_b16 a[0:1], v2 offset:38912
  ds_read_b64_tr_b16 a[2:3], v2 offset:39168
  s_add_u32 s49, s49, 1
  s_cmp_eq_u32 s49, 11
  s_cselect_b32 s49, 0, s49
  s_lshl_b32 s72, s49, 12
  s_add_u32 s49, s49, 1
  v_mfma_f32_32x32x16_bf16 v[32:47], a[12:15], a[212:215], v[32:47]
  ds_read_b64_tr_b16 a[4:5], v3 offset:14336
  ds_read_b64_tr_b16 a[6:7], v3 offset:14592
  s_cmp_eq_u32 s49, 11
  s_cselect_b32 s49, 0, s49
  s_lshl_b32 s73, s49, 12
  s_add_u32 s49, s49, 1
  s_cmp_eq_u32 s49, 11
  s_cselect_b32 s49, 0, s49
  s_waitcnt lgkmcnt(4)
  v_mfma_f32_32x32x16_bf16 v[32:47], a[16:19], a[216:219], v[32:47]
  s_add_u32 m0, s48, 6144
  ds_read_b64_tr_b16 a[8:9], v3 offset:55296
  ds_read_b64_tr_b16 a[10:11], v3 offset:55552
  buffer_load_dwordx4 v7, s[16:19], s89 offen offset:1024 lds
  s_lshl_b32 s74, s49, 12
  s_add_u32 s49, s49, 1
  s_cmp_eq_u32 s49, 11
  s_cselect_b32 s49, 0, s49
  v_mfma_f32_32x32x16_bf16 v[32:47], a[20:23], a[220:223], v[32:47]
  ds_read_b64_tr_b16 a[12:13], v4 offset:30720
  ds_read_b64_tr_b16 a[14:15], v4 offset:30976
  s_lshl_b32 s75, s49, 12
  s_add_u32 s49, s49, 1
  s_cmp_eq_u32 s49, 11
  s_cselect_b32 s49, 0, s49
  s_lshl_b32 s76, s49, 12
  s_waitcnt lgkmcnt(4)
  v_mfma_f32_32x32x16_bf16 v[32:47], a[0:3], a[224:227], v[32:47]
  ds_read_b64_tr_b16 a[16:17], v2 offset:39936
  ds_read_b64_tr_b16 a[18:19], v2 offset:40192
  s_add_u32 s49, s55, s56
  s_add_u32 s50, s49, 0
  s_and_b32 s50, s50, 3
  s_lshl_b32 s77, s50, 12
  s_add_u32 s50, s49, 1
  v_mfma_f32_32x32x16_bf16 v[32:47], a[4:7], a[228:231], v[32:47]
  ds_read_b64_tr_b16 a[20:21], v3 offset:15360
  ds_read_b64_tr_b16 a[22:23], v3 offset:15616
  s_and_b32 s50, s50, 3
  s_lshl_b32 s3, s50, 12
  s_add_u32 s50, s49, 2
  s_and_b32 s50, s50, 3
  s_lshl_b32 s4, s50, 12
  s_add_u32 s50, s49, 3
  s_waitcnt lgkmcnt(4)
  v_mfma_f32_32x32x16_bf16 v[32:47], a[8:11], a[232:235], v[32:47]
  s_add_u32 m0, s48, 6144
  ds_read_b64_tr_b16 a[0:1], v3 offset:56320
  ds_read_b64_tr_b16 a[2:3], v3 offset:56576
  buffer_load_dwordx4 v8, s[16:19], s89 offen offset:2048 lds
  s_and_b32 s50, s50, 3
  s_lshl_b32 s5, s50, 12
  s_mul_i32 s49, s2, 5504
  v_mfma_f32_32x32x16_bf16 v[32:47], a[12:15], a[236:239], v[32:47]
  ds_read_b64_tr_b16 a[4:5], v4 offset:31744
  ds_read_b64_tr_b16 a[6:7], v4 offset:32000
  s_mul_i32 s50, s2, 2048
  s_cmp_eq_u32 s44, 0
  s_cselect_b32 s49, s49, 1073741824
  s_cmp_eq_u32 s44, 1
  s_cselect_b32 s50, s50, 1073741824
  v_lshlrev_b32 v24, 7, v1
  s_waitcnt lgkmcnt(4)
  v_mfma_f32_32x32x16_bf16 v[32:47], a[16:19], a[240:243], v[32:47]
  s_barrier
  ds_read_b64_tr_b16 a[8:9], v2 offset:24576
  ds_read_b64_tr_b16 a[10:11], v2 offset:24832
  v_cmp_gt_u32 vcc, 43, v1
  v_mov_b32 v25, 1073741824
  s_nop 0
  v_cndmask_b32 v25, v25, v24, vcc
  buffer_load_dword a60, v25, s[32:35], s49 offen
  v_mfma_f32_32x32x16_bf16 v[32:47], a[20:23], a[244:247], v[32:47]
  s_add_u32 m0, s48, 9216
  ds_read_b64_tr_b16 a[12:13], v3 offset:0
  ds_read_b64_tr_b16 a[14:15], v3 offset:256
  buffer_load_dwordx4 v6, s[20:23], s89 offen offset:0 lds
  v_cmp_gt_u32 vcc, 16, v1
  v_mov_b32 v25, 1073741824
  s_nop 0
  v_cndmask_b32 v25, v25, v24, vcc
  buffer_load_dword a61, v25, s[36:39], s50 offen
  s_waitcnt lgkmcnt(4)
  v_mfma_f32_32x32x16_bf16 v[32:47], a[0:3], a[248:251], v[32:47]
  ds_read_b64_tr_b16 a[16:17], v3 offset:40960
  ds_read_b64_tr_b16 a[18:19], v3 offset:41216
  v_mfma_f32_32x32x16_bf16 v[32:47], a[4:7], a[252:255], v[32:47]
  ds_read_b64_tr_b16 a[20:21], v4 offset:16384
  ds_read_b64_tr_b16 a[22:23], v4 offset:16640
  s_waitcnt lgkmcnt(4)
  v_mfma_f32_32x32x16_bf16 v[48:63], a[128:131], a[8:11], 0
  s_add_u32 m0, s48, 9216
  ds_read_b64_tr_b16 a[0:1], v2 offset:25600
  ds_read_b64_tr_b16 a[2:3], v2 offset:25856
  buffer_load_dwordx4 v7, s[20:23], s89 offen offset:1024 lds
  v_mfma_f32_32x32x16_bf16 v[48:63], a[132:135], a[12:15], v[48:63]
  ds_read_b64_tr_b16 a[4:5], v3 offset:1024
  ds_read_b64_tr_b16 a[6:7], v3 offset:1280
  s_waitcnt lgkmcnt(4)
  v_mfma_f32_32x32x16_bf16 v[48:63], a[136:139], a[16:19], v[48:63]
  ds_read_b64_tr_b16 a[8:9], v3 offset:41984
  ds_read_b64_tr_b16 a[10:11], v3 offset:42240
  v_cvt_pk_bf16_f32 v80, v32, v33
  v_cvt_pk_bf16_f32 v81, v34, v35
  v_cvt_pk_bf16_f32 v82, v36, v37
  v_mfma_f32_32x32x16_bf16 v[48:63], a[140:143], a[20:23], v[48:63]
  ds_read_b64_tr_b16 a[12:13], v4 offset:17408
  ds_read_b64_tr_b16 a[14:15], v4 offset:17664
  v_cvt_pk_bf16_f32 v83, v38, v39
  v_cvt_pk_bf16_f32 v84, v40, v41
  v_cvt_pk_bf16_f32 v85, v42, v43
  s_waitcnt lgkmcnt(4)
  v_mfma_f32_32x32x16_bf16 v[48:63], a[144:147], a[0:3], v[48:63]
  s_add_u32 m0, s48, 9216
  ds_read_b64_tr_b16 a[16:17], v2 offset:26624
  ds_read_b64_tr_b16 a[18:19], v2 offset:26880
  buffer_load_dwordx4 v8, s[20:23], s89 offen offset:2048 lds
  v_cvt_pk_bf16_f32 v86, v44, v45
  v_mfma_f32_32x32x16_bf16 v[48:63], a[148:151], a[4:7], v[48:63]
  ds_read_b64_tr_b16 a[20:21], v3 offset:2048
  ds_read_b64_tr_b16 a[22:23], v3 offset:2304
  v_cvt_pk_bf16_f32 v87, v46, v47
  v_mfma_f32_32x32x16_bf16 v[64:79], a[40:43], v[80:83], 0
  s_nop 0
  v_mfma_f32_32x32x16_bf16 v[64:79], a[44:47], v[84:87], v[64:79]
  s_waitcnt lgkmcnt(4)
  v_mfma_f32_32x32x16_bf16 v[48:63], a[152:155], a[8:11], v[48:63]
  ds_read_b64_tr_b16 a[0:1], v3 offset:43008
  ds_read_b64_tr_b16 a[2:3], v3 offset:43264
  v_mfma_f32_32x32x16_bf16 v[48:63], a[156:159], a[12:15], v[48:63]
  s_add_u32 m0, s48, 12288
  ds_read_b64_tr_b16 a[4:5], v4 offset:18432
  ds_read_b64_tr_b16 a[6:7], v4 offset:18688
  buffer_load_dwordx4 v6, s[16:19], s90 offen offset:0 lds
  s_waitcnt lgkmcnt(4)
  v_mfma_f32_32x32x16_bf16 v[48:63], a[160:163], a[16:19], v[48:63]
  ds_read_b64_tr_b16 a[8:9], v2 offset:27648
  ds_read_b64_tr_b16 a[10:11], v2 offset:27904
  v_max3_f32 v17, v64, v65, v66
  v_min3_f32 v18, v64, v65, v66
  v_max3_f32 v17, v17, v67, v68
  v_min3_f32 v18, v18, v67, v68
  v_mfma_f32_32x32x16_bf16 v[48:63], a[164:167], a[20:23], v[48:63]
  ds_read_b64_tr_b16 a[12:13], v3 offset:3072
  ds_read_b64_tr_b16 a[14:15], v3 offset:3328
  v_max3_f32 v17, v17, v69, v70
  v_min3_f32 v18, v18, v69, v70
  v_max3_f32 v17, v17, v71, v72
  s_waitcnt lgkmcnt(4)
  v_mfma_f32_32x32x16_bf16 v[48:63], a[168:171], a[0:3], v[48:63]
  s_add_u32 m0, s48, 12288
  ds_read_b64_tr_b16 a[16:17], v3 offset:44032
  ds_read_b64_tr_b16 a[18:19], v3 offset:44288
  buffer_load_dwordx4 v7, s[16:19], s90 offen offset:1024 lds
  v_min3_f32 v18, v18, v71, v72
  v_mfma_f32_32x32x16_bf16 v[48:63], a[172:175], a[4:7], v[48:63]
  ds_read_b64_tr_b16 a[20:21], v4 offset:19456
  ds_read_b64_tr_b16 a[22:23], v4 offset:19712
  v_max3_f32 v17, v17, v73, v74
  v_min3_f32 v18, v18, v73, v74
  v_max3_f32 v17, v17, v75, v76
  v_min3_f32 v18, v18, v75, v76
  s_waitcnt lgkmcnt(4)
  v_mfma_f32_32x32x16_bf16 v[48:63], a[176:179], a[8:11], v[48:63]
  ds_read_b64_tr_b16 a[0:1], v2 offset:28672
  ds_read_b64_tr_b16 a[2:3], v2 offset:28928
  v_max3_f32 v17, v17, v77, v78
  v_min3_f32 v18, v18, v77, v78
  v_max_f32 v17, v17, v79
  v_mfma_f32_32x32x16_bf16 v[48:63], a[180:183], a[12:15], v[48:63]
  s_add_u32 m0, s48, 12288
  ds_read_b64_tr_b16 a[4:5], v3 offset:4096
  ds_read_b64_tr_b16 a[6:7], v3 offset:4352
  buffer_load_dwordx4 v8, s[16:19], s90 offen offset:2048 lds
  v_min_f32 v18, v18, v79
  s_waitcnt lgkmcnt(4)
  v_mfma_f32_32x32x16_bf16 v[48:63], a[184:187], a[16:19], v[48:63]
  ds_read_b64_tr_b16 a[8:9], v3 offset:45056
  ds_read_b64_tr_b16 a[10:11], v3 offset:45312
  v_mul_f32 v17, v17, v14
  v_mul_f32 v18, v18, v14
  v_fma_f32 v80, v64, v14, -v17
  v_mfma_f32_32x32x16_bf16 v[48:63], a[188:191], a[20:23], v[48:63]
  ds_read_b64_tr_b16 a[12:13], v4 offset:20480
  ds_read_b64_tr_b16 a[14:15], v4 offset:20736
  v_fma_f32 v96, -v64, v14, v18
  v_fma_f32 v81, v65, v14, -v17
  v_fma_f32 v97, -v65, v14, v18
  v_fma_f32 v82, v66, v14, -v17
  s_waitcnt lgkmcnt(4)
  v_mfma_f32_32x32x16_bf16 v[48:63], a[192:195], a[0:3], v[48:63]
  ds_read_b64_tr_b16 a[16:17], v2 offset:29696
  ds_read_b64_tr_b16 a[18:19], v2 offset:29952
  v_fma_f32 v98, -v66, v14, v18
  v_fma_f32 v83, v67, v14, -v17
  v_fma_f32 v99, -v67, v14, v18
  v_mfma_f32_32x32x16_bf16 v[48:63], a[196:199], a[4:7], v[48:63]
  s_add_u32 m0, s48, 15360
  ds_read_b64_tr_b16 a[20:21], v3 offset:5120
  ds_read_b64_tr_b16 a[22:23], v3 offset:5376
  buffer_load_dwordx4 v6, s[20:23], s90 offen offset:0 lds
  v_fma_f32 v84, v68, v14, -v17
  s_waitcnt lgkmcnt(4)
  v_mfma_f32_32x32x16_bf16 v[48:63], a[200:203], a[8:11], v[48:63]
  ds_read_b64_tr_b16 a[0:1], v3 offset:46080
  ds_read_b64_tr_b16 a[2:3], v3 offset:46336
  v_fma_f32 v100, -v68, v14, v18
  v_fma_f32 v85, v69, v14, -v17
  v_fma_f32 v101, -v69, v14, v18
  v_mfma_f32_32x32x16_bf16 v[48:63], a[204:207], a[12:15], v[48:63]
  ds_read_b64_tr_b16 a[4:5], v4 offset:21504
  ds_read_b64_tr_b16 a[6:7], v4 offset:21760
  v_fma_f32 v86, v70, v14, -v17
  v_fma_f32 v102, -v70, v14, v18
  v_fma_f32 v87, v71, v14, -v17
  v_fma_f32 v103, -v71, v14, v18
  s_waitcnt lgkmcnt(4)
  v_mfma_f32_32x32x16_bf16 v[48:63], a[208:211], a[16:19], v[48:63]
  s_add_u32 m0, s48, 15360
  ds_read_b64_tr_b16 a[8:9], v2 offset:30720
  ds_read_b64_tr_b16 a[10:11], v2 offset:30976
  buffer_load_dwordx4 v7, s[20:23], s90 offen offset:1024 lds
  v_fma_f32 v88, v72, v14, -v17
  v_mfma_f32_32x32x16_bf16 v[48:63], a[212:215], a[20:23], v[48:63]
  ds_read_b64_tr_b16 a[12:13], v3 offset:6144
  ds_read_b64_tr_b16 a[14:15], v3 offset:6400
  v_fma_f32 v104, -v72, v14, v18
  v_fma_f32 v89, v73, v14, -v17
  v_fma_f32 v105, -v73, v14, v18
  s_waitcnt lgkmcnt(4)
  v_mfma_f32_32x32x16_bf16 v[48:63], a[216:219], a[0:3], v[48:63]
  ds_read_b64_tr_b16 a[16:17], v3 offset:47104
  ds_read_b64_tr_b16 a[18:19], v3 offset:47360
  v_fma_f32 v90, v74, v14, -v17
  v_fma_f32 v106, -v74, v14, v18
  v_fma_f32 v91, v75, v14, -v17
  v_mfma_f32_32x32x16_bf16 v[48:63], a[220:223], a[4:7], v[48:63]
  s_add_u32 m0, s48, 15360
  ds_read_b64_tr_b16 a[20:21], v4 offset:22528
  ds_read_b64_tr_b16 a[22:23], v4 offset:22784
  buffer_load_dwordx4 v8, s[20:23], s90 offen offset:2048 lds
  v_fma_f32 v107, -v75, v14, v18
  v_fma_f32 v92, v76, v14, -v17
  s_waitcnt lgkmcnt(4)
  v_mfma_f32_32x32x16_bf16 v[48:63], a[224:227], a[8:11], v[48:63]
  ds_read_b64_tr_b16 a[0:1], v2 offset:31744
  ds_read_b64_tr_b16 a[2:3], v2 offset:32000
  v_fma_f32 v108, -v76, v14, v18
  v_fma_f32 v93, v77, v14, -v17
  v_fma_f32 v109, -v77, v14, v18
  v_mfma_f32_32x32x16_bf16 v[48:63], a[228:231], a[12:15], v[48:63]
  ds_read_b64_tr_b16 a[4:5], v3 offset:7168
  ds_read_b64_tr_b16 a[6:7], v3 offset:7424
  v_fma_f32 v94, v78, v14, -v17
  v_fma_f32 v110, -v78, v14, v18
  v_fma_f32 v95, v79, v14, -v17
  s_waitcnt lgkmcnt(4)
  v_mfma_f32_32x32x16_bf16 v[48:63], a[232:235], a[16:19], v[48:63]
  ds_read_b64_tr_b16 a[8:9], v3 offset:48128
  ds_read_b64_tr_b16 a[10:11], v3 offset:48384
  v_fma_f32 v111, -v79, v14, v18
  v_exp_f32 v80, v80
  v_mfma_f32_32x32x16_bf16 v[48:63], a[236:239], a[20:23], v[48:63]
  ds_read_b64_tr_b16 a[12:13], v4 offset:23552
  ds_read_b64_tr_b16 a[14:15], v4 offset:23808
  v_exp_f32 v81, v81
  v_exp_f32 v82, v82
  s_waitcnt lgkmcnt(4)
  v_mfma_f32_32x32x16_bf16 v[48:63], a[240:243], a[0:3], v[48:63]
  s_waitcnt vmcnt(14)
  s_barrier
  ds_read_b64_tr_b16 a[16:17], v9 offset:0
  ds_read_b64_tr_b16 a[18:19], v9 offset:768
  v_exp_f32 v83, v83
  v_mfma_f32_32x32x16_bf16 v[48:63], a[244:247], a[4:7], v[48:63]
  ds_read_b64_tr_b16 a[20:21], v9 offset:64
  ds_read_b64_tr_b16 a[22:23], v9 offset:832
  v_exp_f32 v84, v84
  v_exp_f32 v85, v85
  s_waitcnt lgkmcnt(4)
  v_mfma_f32_32x32x16_bf16 v[48:63], a[248:251], a[8:11], v[48:63]
  ds_read_b64_tr_b16 a[0:1], v9 offset:128
  ds_read_b64_tr_b16 a[2:3], v9 offset:896
  v_exp_f32 v86, v86
  v_mfma_f32_32x32x16_bf16 v[48:63], a[252:255], a[12:15], v[48:63]
  ds_read_b64_tr_b16 a[4:5], v9 offset:3072
  ds_read_b64_tr_b16 a[6:7], v9 offset:3840
  v_exp_f32 v87, v87
  v_exp_f32 v88, v88
  s_waitcnt lgkmcnt(4)
  v_mfma_f32_32x32x16_bf16 v[128:143], a[16:19], a[128:131], 0
  s_add_u32 m0, s48, 18432
  ds_read_b64_tr_b16 a[8:9], v9 offset:3136
  ds_read_b64_tr_b16 a[10:11], v9 offset:3904
  buffer_load_dwordx4 v6, s[16:19], s91 offen offset:0 lds
  v_exp_f32 v89, v89
  v_mfma_f32_32x32x16_bf16 v[144:159], a[20:23], a[128:131], 0
  ds_read_b64_tr_b16 a[12:13], v9 offset:3200
  ds_read_b64_tr_b16 a[14:15], v9 offset:3968
  v_exp_f32 v90, v90
  s_waitcnt lgkmcnt(4)
  v_mfma_f32_32x32x16_bf16 v[160:175], a[0:3], a[128:131], 0
  ds_read_b64_tr_b16 a[16:17], v9 offset:40960
  ds_read_b64_tr_b16 a[18:19], v9 offset:41728
  v_exp_f32 v91, v91
  v_exp_f32 v92, v92
  v_mfma_f32_32x32x16_bf16 v[176:191], a[4:7], a[128:131], 0
  s_add_u32 m0, s48, 18432
  ds_read_b64_tr_b16 a[20:21], v9 offset:41024
  ds_read_b64_tr_b16 a[22:23], v9 offset:41792
  buffer_load_dwordx4 v7, s[16:19], s91 offen offset:1024 lds
  v_exp_f32 v93, v93
  s_waitcnt lgkmcnt(4)
  v_mfma_f32_32x32x16_bf16 v[192:207], a[8:11], a[128:131], 0
  ds_read_b64_tr_b16 a[0:1], v9 offset:41088
  ds_read_b64_tr_b16 a[2:3], v9 offset:41856
  v_exp_f32 v94, v94
  v_mfma_f32_32x32x16_bf16 v[208:223], a[12:15], a[128:131], 0
  ds_read_b64_tr_b16 a[4:5], v9 offset:44032
  ds_read_b64_tr_b16 a[6:7], v9 offset:44800
  v_exp_f32 v95, v95
  v_exp_f32 v96, v96
  s_waitcnt lgkmcnt(4)
  v_mfma_f32_32x32x16_bf16 v[128:143], a[16:19], a[132:135], v[128:143]
  s_add_u32 m0, s48, 18432
  ds_read_b64_tr_b16 a[8:9], v9 offset:44096
  ds_read_b64_tr_b16 a[10:11], v9 offset:44864
  buffer_load_dwordx4 v8, s[16:19], s91 offen offset:2048 lds
  v_mfma_f32_32x32x16_bf16 v[144:159], a[20:23], a[132:135], v[144:159]
  ds_read_b64_tr_b16 a[12:13], v9 offset:44160
  ds_read_b64_tr_b16 a[14:15], v9 offset:44928
  v_exp_f32 v97, v97
  v_exp_f32 v98, v98
  s_waitcnt lgkmcnt(4)
  v_mfma_f32_32x32x16_bf16 v[160:175], a[0:3], a[132:135], v[160:175]
  ds_read_b64_tr_b16 a[16:17], v10 offset:16384
  ds_read_b64_tr_b16 a[18:19], v10 offset:17152
  v_exp_f32 v99, v99
  v_exp_f32 v100, v100
  v_mfma_f32_32x32x16_bf16 v[176:191], a[4:7], a[132:135], v[176:191]
  s_add_u32 m0, s48, 21504
  ds_read_b64_tr_b16 a[20:21], v10 offset:16448
  ds_read_b64_tr_b16 a[22:23], v10 offset:17216
  buffer_load_dwordx4 v6, s[20:23], s91 offen offset:0 lds
  s_waitcnt lgkmcnt(4)
  v_mfma_f32_32x32x16_bf16 v[192:207], a[8:11], a[132:135], v[192:207]
  ds_read_b64_tr_b16 a[0:1], v10 offset:16512
  ds_read_b64_tr_b16 a[2:3], v10 offset:17280
  v_exp_f32 v101, v101
  v_exp_f32 v102, v102
  v_mfma_f32_32x32x16_bf16 v[208:223], a[12:15], a[132:135], v[208:223]
  ds_read_b64_tr_b16 a[4:5], v10 offset:19456
  ds_read_b64_tr_b16 a[6:7], v10 offset:20224
  v_exp_f32 v103, v103
  v_exp_f32 v104, v104
  s_waitcnt lgkmcnt(4)
  v_mfma_f32_32x32x16_bf16 v[128:143], a[16:19], a[136:139], v[128:143]
  s_add_u32 m0, s48, 21504
  ds_read_b64_tr_b16 a[8:9], v10 offset:19520
  ds_read_b64_tr_b16 a[10:11], v10 offset:20288
  buffer_load_dwordx4 v7, s[20:23], s91 offen offset:1024 lds
  v_mfma_f32_32x32x16_bf16 v[144:159], a[20:23], a[136:139], v[144:159]
  ds_read_b64_tr_b16 a[12:13], v10 offset:19584
  ds_read_b64_tr_b16 a[14:15], v10 offset:20352
  v_exp_f32 v105, v105
  v_exp_f32 v106, v106
  s_waitcnt lgkmcnt(4)
  v_mfma_f32_32x32x16_bf16 v[160:175], a[0:3], a[136:139], v[160:175]
  ds_read_b64_tr_b16 a[16:17], v10 offset:57344
  ds_read_b64_tr_b16 a[18:19], v10 offset:58112
  v_exp_f32 v107, v107
  v_mfma_f32_32x32x16_bf16 v[176:191], a[4:7], a[136:139], v[176:191]
  s_add_u32 m0, s48, 21504
  ds_read_b64_tr_b16 a[20:21], v10 offset:57408
  ds_read_b64_tr_b16 a[22:23], v10 offset:58176
  buffer_load_dwordx4 v8, s[20:23], s91 offen offset:2048 lds
  v_exp_f32 v108, v108
  s_waitcnt lgkmcnt(4)
  v_mfma_f32_32x32x16_bf16 v[192:207], a[8:11], a[136:139], v[192:207]
  ds_read_b64_tr_b16 a[0:1], v10 offset:57472
  ds_read_b64_tr_b16 a[2:3], v10 offset:58240
  v_exp_f32 v109, v109
  v_exp_f32 v110, v110
  v_mfma_f32_32x32x16_bf16 v[208:223], a[12:15], a[136:139], v[208:223]
  ds_read_b64_tr_b16 a[4:5], v10 offset:60416
  ds_read_b64_tr_b16 a[6:7], v10 offset:61184
  v_exp_f32 v111, v111
  s_waitcnt lgkmcnt(4)
  v_mfma_f32_32x32x16_bf16 v[128:143], a[16:19], a[140:143], v[128:143]
  ds_read_b64_tr_b16 a[8:9], v10 offset:60480
  ds_read_b64_tr_b16 a[10:11], v10 offset:61248
  v_add_f32 v19, v80, v81
  v_add_f32 v20, v96, v97
  v_add_f32 v19, v19, v82
  v_mfma_f32_32x32x16_bf16 v[144:159], a[20:23], a[140:143], v[144:159]
  ds_read_b64_tr_b16 a[12:13], v10 offset:60544
  ds_read_b64_tr_b16 a[14:15], v10 offset:61312
  v_add_f32 v20, v20, v98
  v_add_f32 v19, v19, v83
  v_add_f32 v20, v20, v99
  v_add_f32 v19, v19, v84
  s_waitcnt lgkmcnt(4)
  v_mfma_f32_32x32x16_bf16 v[160:175], a[0:3], a[140:143], v[160:175]
  s_waitcnt vmcnt(12)
  s_barrier
  ds_read_b64_tr_b16 a[16:17], v9 offset:6144
  ds_read_b64_tr_b16 a[18:19], v9 offset:6912
  v_add_f32 v20, v20, v100
  v_add_f32 v19, v19, v85
  v_mfma_f32_32x32x16_bf16 v[176:191], a[4:7], a[140:143], v[176:191]
  ds_read_b64_tr_b16 a[20:21], v9 offset:6208
  ds_read_b64_tr_b16 a[22:23], v9 offset:6976
  v_add_f32 v20, v20, v101
  v_add_f32 v19, v19, v86
  v_add_f32 v20, v20, v102
  s_waitcnt lgkmcnt(4)
  v_mfma_f32_32x32x16_bf16 v[192:207], a[8:11], a[140:143], v[192:207]
  ds_read_b64_tr_b16 a[0:1], v9 offset:6272
  ds_read_b64_tr_b16 a[2:3], v9 offset:7040
  v_add_f32 v19, v19, v87
  v_add_f32 v20, v20, v103
  v_add_f32 v19, v19, v88
  v_mfma_f32_32x32x16_bf16 v[208:223], a[12:15], a[140:143], v[208:223]
  ds_read_b64_tr_b16 a[4:5], v9 offset:9216
  ds_read_b64_tr_b16 a[6:7], v9 offset:9984
  v_add_f32 v20, v20, v104
  v_add_f32 v19, v19, v89
  v_add_f32 v20, v20, v105
  v_add_f32 v19, v19, v90
  s_waitcnt lgkmcnt(4)
  v_mfma_f32_32x32x16_bf16 v[128:143], a[16:19], a[144:147], v[128:143]
  ds_read_b64_tr_b16 a[8:9], v9 offset:9280
  ds_read_b64_tr_b16 a[10:11], v9 offset:10048
  v_add_f32 v20, v20, v106
  v_add_f32 v19, v19, v91
  v_add_f32 v20, v20, v107
  v_mfma_f32_32x32x16_bf16 v[144:159], a[20:23], a[144:147], v[144:159]
  ds_read_b64_tr_b16 a[12:13], v9 offset:9344
  ds_read_b64_tr_b16 a[14:15], v9 offset:10112
  v_add_f32 v19, v19, v92
  v_add_f32 v20, v20, v108
  v_add_f32 v19, v19, v93
  s_waitcnt lgkmcnt(4)
  v_mfma_f32_32x32x16_bf16 v[160:175], a[0:3], a[144:147], v[160:175]
  ds_read_b64_tr_b16 a[16:17], v9 offset:47104
  ds_read_b64_tr_b16 a[18:19], v9 offset:47872
  s_add_u32 m0, s63, 24576
  s_lshl4_add_u32 s98, s28, s61
  buffer_load_dwordx4 v12, s[32:35], s98 offen lds
  v_mfma_f32_32x32x16_bf16 v[176:191], a[4:7], a[144:147], v[176:191]
  ds_read_b64_tr_b16 a[20:21], v9 offset:47168
  ds_read_b64_tr_b16 a[22:23], v9 offset:47936
  v_add_f32 v20, v20, v109
  v_add_f32 v19, v19, v94
  v_add_f32 v20, v20, v110
  v_add_f32 v19, v19, v95
  s_waitcnt lgkmcnt(4)
  v_mfma_f32_32x32x16_bf16 v[192:207], a[8:11], a[144:147], v[192:207]
  ds_read_b64_tr_b16 a[0:1], v9 offset:47232
  ds_read_b64_tr_b16 a[2:3], v9 offset:48000
  s_add_u32 m0, s63, 26624
  s_lshl4_add_u32 s98, s28, s61
  buffer_load_dwordx4 v227, s[32:35], s98 offen lds
  v_mfma_f32_32x32x16_bf16 v[208:223], a[12:15], a[144:147], v[208:223]
  ds_read_b64_tr_b16 a[4:5], v9 offset:50176
  ds_read_b64_tr_b16 a[6:7], v9 offset:50944
  v_add_f32 v20, v20, v111
  v_rcp_f32 v19, v19
  v_rcp_f32 v20, v20
  s_waitcnt lgkmcnt(4)
  v_mfma_f32_32x32x16_bf16 v[128:143], a[16:19], a[148:151], v[128:143]
  ds_read_b64_tr_b16 a[8:9], v9 offset:50240
  ds_read_b64_tr_b16 a[10:11], v9 offset:51008
  v_mul_f32 v80, v80, v19
  v_mul_f32 v96, v96, v20
  v_mfma_f32_32x32x16_bf16 v[144:159], a[20:23], a[148:151], v[144:159]
  ds_read_b64_tr_b16 a[12:13], v9 offset:50304
  ds_read_b64_tr_b16 a[14:15], v9 offset:51072
  s_add_u32 m0, s63, 28672
  s_lshl4_add_u32 s98, s28, s61
  buffer_load_dwordx4 v228, s[32:35], s98 offen lds
  s_waitcnt lgkmcnt(4)
  v_mfma_f32_32x32x16_bf16 v[160:175], a[0:3], a[148:151], v[160:175]
  ds_read_b64_tr_b16 a[16:17], v10 offset:22528
  ds_read_b64_tr_b16 a[18:19], v10 offset:23296
  v_mul_f32 v81, v81, v19
  v_mul_f32 v97, v97, v20
  v_mul_f32 v82, v82, v19
  v_mfma_f32_32x32x16_bf16 v[176:191], a[4:7], a[148:151], v[176:191]
  ds_read_b64_tr_b16 a[20:21], v10 offset:22592
  ds_read_b64_tr_b16 a[22:23], v10 offset:23360
  s_add_u32 m0, s63, 30720
  s_lshl4_add_u32 s98, s28, s61
  buffer_load_dwordx4 v229, s[32:35], s98 offen lds
  v_mul_f32 v98, v98, v20
  s_waitcnt lgkmcnt(4)
  v_mfma_f32_32x32x16_bf16 v[192:207], a[8:11], a[148:151], v[192:207]
  ds_read_b64_tr_b16 a[0:1], v10 offset:22656
  ds_read_b64_tr_b16 a[2:3], v10 offset:23424
  v_mul_f32 v83, v83, v19
  v_mul_f32 v99, v99, v20
  v_mul_f32 v84, v84, v19
  v_mfma_f32_32x32x16_bf16 v[208:223], a[12:15], a[148:151], v[208:223]
  ds_read_b64_tr_b16 a[4:5], v10 offset:25600
  ds_read_b64_tr_b16 a[6:7], v10 offset:26368
  v_mul_f32 v100, v100, v20
  v_mul_f32 v85, v85, v19
  v_mul_f32 v101, v101, v20
  s_waitcnt lgkmcnt(4)
  v_mfma_f32_32x32x16_bf16 v[128:143], a[16:19], a[152:155], v[128:143]
  ds_read_b64_tr_b16 a[8:9], v10 offset:25664
  ds_read_b64_tr_b16 a[10:11], v10 offset:26432
  s_add_u32 m0, s63, 65536
  s_lshl4_add_u32 s98, s29, s61
  buffer_load_dwordx4 v12, s[32:35], s98 offen lds
  v_mfma_f32_32x32x16_bf16 v[144:159], a[20:23], a[152:155], v[144:159]
  ds_read_b64_tr_b16 a[12:13], v10 offset:25728
  ds_read_b64_tr_b16 a[14:15], v10 offset:26496
  v_mul_f32 v86, v86, v19
  v_mul_f32 v102, v102, v20
  v_mul_f32 v87, v87, v19
  v_mul_f32 v103, v103, v20
  s_waitcnt lgkmcnt(4)
  v_mfma_f32_32x32x16_bf16 v[160:175], a[0:3], a[152:155], v[160:175]
  ds_read_b64_tr_b16 a[16:17], v10 offset:63488
  ds_read_b64_tr_b16 a[18:19], v10 offset:64256
  v_mul_f32 v88, v88, v19
  v_mul_f32 v104, v104, v20
  v_mul_f32 v89, v89, v19
  v_mfma_f32_32x32x16_bf16 v[176:191], a[4:7], a[152:155], v[176:191]
  ds_read_b64_tr_b16 a[20:21], v10 offset:63552
  ds_read_b64_tr_b16 a[22:23], v10 offset:64320
  s_add_u32 m0, s63, 67584
  s_lshl4_add_u32 s98, s29, s61
  buffer_load_dwordx4 v227, s[32:35], s98 offen lds
  v_mul_f32 v105, v105, v20
  s_waitcnt lgkmcnt(4)
  v_mfma_f32_32x32x16_bf16 v[192:207], a[8:11], a[152:155], v[192:207]
  ds_read_b64_tr_b16 a[0:1], v10 offset:63616
  ds_read_b64_tr_b16 a[2:3], v10 offset:64384
  v_mul_f32 v90, v90, v19
  v_mul_f32 v106, v106, v20
  v_mfma_f32_32x32x16_bf16 v[208:223], a[12:15], a[152:155], v[208:223]
  ds_read_b64_tr_b16 a[4:5], v11 offset:1024
  ds_read_b64_tr_b16 a[6:7], v11 offset:1792
  s_add_u32 m0, s63, 69632
  s_lshl4_add_u32 s98, s29, s61
  buffer_load_dwordx4 v228, s[32:35], s98 offen lds
  v_mul_f32 v91, v91, v19
  s_waitcnt lgkmcnt(4)
  v_mfma_f32_32x32x16_bf16 v[128:143], a[16:19], a[156:159], v[128:143]
  ds_read_b64_tr_b16 a[8:9], v11 offset:1088
  ds_read_b64_tr_b16 a[10:11], v11 offset:1856
  v_mul_f32 v107, v107, v20
  v_mul_f32 v92, v92, v19
  v_mul_f32 v108, v108, v20
  v_mfma_f32_32x32x16_bf16 v[144:159], a[20:23], a[156:159], v[144:159]
  ds_read_b64_tr_b16 a[12:13], v11 offset:1152
  ds_read_b64_tr_b16 a[14:15], v11 offset:1920
  v_mul_f32 v93, v93, v19
  v_mul_f32 v109, v109, v20
  v_mul_f32 v94, v94, v19
  v_mul_f32 v110, v110, v20
  s_waitcnt lgkmcnt(4)
  v_mfma_f32_32x32x16_bf16 v[160:175], a[0:3], a[156:159], v[160:175]
  s_waitcnt vmcnt(13)
  s_barrier
  ds_read_b64_tr_b16 a[16:17], v9 offset:12288
  ds_read_b64_tr_b16 a[18:19], v9 offset:13056
  s_add_u32 m0, s63, 71680
  s_lshl4_add_u32 s98, s29, s61
  buffer_load_dwordx4 v229, s[32:35], s98 offen lds
  v_mfma_f32_32x32x16_bf16 v[176:191], a[4:7], a[156:159], v[176:191]
  s_add_u32 m0, s48, 0
  ds_read_b64_tr_b16 a[20:21], v9 offset:12352
  ds_read_b64_tr_b16 a[22:23], v9 offset:13120
  buffer_load_dwordx4 v6, s[16:19], s92 offen offset:0 lds
  v_mul_f32 v95, v95, v19
  s_waitcnt lgkmcnt(4)
  v_mfma_f32_32x32x16_bf16 v[192:207], a[8:11], a[156:159], v[192:207]
  ds_read_b64_tr_b16 a[0:1], v9 offset:12416
  ds_read_b64_tr_b16 a[2:3], v9 offset:13184
  v_mul_f32 v111, v111, v20
  v_cvt_pk_bf16_f32 v112, v80, v81
  v_cvt_pk_bf16_f32 v113, v82, v83
  v_mfma_f32_32x32x16_bf16 v[208:223], a[12:15], a[156:159], v[208:223]
  ds_read_b64_tr_b16 a[4:5], v9 offset:15360
  ds_read_b64_tr_b16 a[6:7], v9 offset:16128
  v_cvt_pk_bf16_f32 v114, v84, v85
  v_cvt_pk_bf16_f32 v115, v86, v87
  v_cvt_pk_bf16_f32 v116, v88, v89
  v_cvt_pk_bf16_f32 v117, v90, v91
  s_waitcnt lgkmcnt(4)
  v_mfma_f32_32x32x16_bf16 v[128:143], a[16:19], a[160:163], v[128:143]
  s_add_u32 m0, s48, 0
  ds_read_b64_tr_b16 a[8:9], v9 offset:15424
  ds_read_b64_tr_b16 a[10:11], v9 offset:16192
  buffer_load_dwordx4 v7, s[16:19], s92 offen offset:1024 lds
  v_cvt_pk_bf16_f32 v118, v92, v93
  v_mfma_f32_32x32x16_bf16 v[144:159], a[20:23], a[160:163], v[144:159]
  ds_read_b64_tr_b16 a[12:13], v9 offset:15488
  ds_read_b64_tr_b16 a[14:15], v9 offset:16256
  v_cvt_pk_bf16_f32 v119, v94, v95
  v_cvt_pk_bf16_f32 v120, v96, v97
  v_cvt_pk_bf16_f32 v121, v98, v99
  s_waitcnt lgkmcnt(4)
  v_mfma_f32_32x32x16_bf16 v[160:175], a[0:3], a[160:163], v[160:175]
  ds_read_b64_tr_b16 a[16:17], v9 offset:53248
  ds_read_b64_tr_b16 a[18:19], v9 offset:54016
  v_cvt_pk_bf16_f32 v122, v100, v101
  v_cvt_pk_bf16_f32 v123, v102, v103
  v_cvt_pk_bf16_f32 v124, v104, v105
  v_mfma_f32_32x32x16_bf16 v[176:191], a[4:7], a[160:163], v[176:191]
  s_add_u32 m0, s48, 0
  ds_read_b64_tr_b16 a[20:21], v9 offset:53312
  ds_read_b64_tr_b16 a[22:23], v9 offset:54080
  buffer_load_dwordx4 v8, s[16:19], s92 offen offset:2048 lds
  v_cvt_pk_bf16_f32 v125, v106, v107
  v_cvt_pk_bf16_f32 v126, v108, v109
  s_waitcnt lgkmcnt(4)
  v_mfma_f32_32x32x16_bf16 v[192:207], a[8:11], a[160:163], v[192:207]
  ds_read_b64_tr_b16 a[0:1], v9 offset:53376
  ds_read_b64_tr_b16 a[2:3], v9 offset:54144
  v_cvt_pk_bf16_f32 v127, v110, v111
  v_cvt_pk_bf16_f32 v24, v15, v15
  v_lshlrev_b32 v25, 16, v24
  v_mfma_f32_32x32x16_bf16 v[208:223], a[12:15], a[160:163], v[208:223]
  ds_read_b64_tr_b16 a[4:5], v9 offset:56320
  ds_read_b64_tr_b16 a[6:7], v9 offset:57088
  v_sub_f32 v25, v15, v25
  v_cvt_pk_bf16_f32 v24, v15, v25
  v_mov_b32 v25, 0
  s_waitcnt lgkmcnt(4)
  v_mfma_f32_32x32x16_bf16 v[128:143], a[16:19], a[164:167], v[128:143]
  ds_read_b64_tr_b16 a[8:9], v9 offset:56384
  ds_read_b64_tr_b16 a[10:11], v9 offset:57152
  v_mov_b32 v26, 0
  v_mov_b32 v27, 0
  v_mfma_f32_32x32x16_bf16 v[64:79], v[112:115], a[32:35], 0
  v_mfma_f32_32x32x16_bf16 v[144:159], a[20:23], a[164:167], v[144:159]
  s_add_u32 m0, s48, 3072
  ds_read_b64_tr_b16 a[12:13], v9 offset:56448
  ds_read_b64_tr_b16 a[14:15], v9 offset:57216
  buffer_load_dwordx4 v6, s[20:23], s92 offen offset:0 lds
  v_mfma_f32_32x32x16_bf16 v[80:95], v[120:123], a[32:35], 0
  v_mfma_f32_32x32x16_bf16 v[32:47], v[24:27], a[48:51], 0
  s_waitcnt lgkmcnt(4)
  v_mfma_f32_32x32x16_bf16 v[160:175], a[0:3], a[164:167], v[160:175]
  ds_read_b64_tr_b16 a[16:17], v10 offset:28672
  ds_read_b64_tr_b16 a[18:19], v10 offset:29440
  v_mfma_f32_32x32x16_bf16 v[64:79], v[116:119], a[36:39], v[64:79]
  v_mfma_f32_32x32x16_bf16 v[80:95], v[124:127], a[36:39], v[80:95]
  v_mfma_f32_32x32x16_bf16 v[176:191], a[4:7], a[164:167], v[176:191]
  ds_read_b64_tr_b16 a[20:21], v10 offset:28736
  ds_read_b64_tr_b16 a[22:23], v10 offset:29504
  s_waitcnt lgkmcnt(4)
  v_mfma_f32_32x32x16_bf16 v[192:207], a[8:11], a[164:167], v[192:207]
  s_add_u32 m0, s48, 3072
  ds_read_b64_tr_b16 a[0:1], v10 offset:28800
  ds_read_b64_tr_b16 a[2:3], v10 offset:29568
  buffer_load_dwordx4 v7, s[20:23], s92 offen offset:1024 lds
  v_mfma_f32_32x32x16_bf16 v[208:223], a[12:15], a[164:167], v[208:223]
  ds_read_b64_tr_b16 a[4:5], v10 offset:31744
  ds_read_b64_tr_b16 a[6:7], v10 offset:32512
  v_mul_f32 v48, v48, v32
  v_mul_f32 v49, v49, v33
  v_mul_f32 v50, v50, v34
  v_mul_f32 v51, v51, v35
  s_waitcnt lgkmcnt(4)
  v_mfma_f32_32x32x16_bf16 v[128:143], a[16:19], a[168:171], v[128:143]
  ds_read_b64_tr_b16 a[8:9], v10 offset:31808
  ds_read_b64_tr_b16 a[10:11], v10 offset:32576
  v_mul_f32 v52, v52, v36
  v_mul_f32 v53, v53, v37
  v_mul_f32 v54, v54, v38
  v_mfma_f32_32x32x16_bf16 v[144:159], a[20:23], a[168:171], v[144:159]
  s_add_u32 m0, s48, 3072
  ds_read_b64_tr_b16 a[12:13], v10 offset:31872
  ds_read_b64_tr_b16 a[14:15], v10 offset:32640
  buffer_load_dwordx4 v8, s[20:23], s92 offen offset:2048 lds
  v_mul_f32 v55, v55, v39
  v_mul_f32 v56, v56, v40
  s_waitcnt lgkmcnt(4)
  v_mfma_f32_32x32x16_bf16 v[160:175], a[0:3], a[168:171], v[160:175]
  ds_read_b64_tr_b16 a[16:17], v11 offset:4096
  ds_read_b64_tr_b16 a[18:19], v11 offset:4864
  v_mul_f32 v57, v57, v41
  v_mul_f32 v58, v58, v42
  v_mul_f32 v59, v59, v43
  v_mfma_f32_32x32x16_bf16 v[176:191], a[4:7], a[168:171], v[176:191]
  ds_read_b64_tr_b16 a[20:21], v11 offset:4160
  ds_read_b64_tr_b16 a[22:23], v11 offset:4928
  v_mul_f32 v60, v60, v44
  v_mul_f32 v61, v61, v45
  v_mul_f32 v62, v62, v46
  s_waitcnt lgkmcnt(4)
  v_mfma_f32_32x32x16_bf16 v[192:207], a[8:11], a[168:171], v[192:207]
  ds_read_b64_tr_b16 a[0:1], v11 offset:4224
  ds_read_b64_tr_b16 a[2:3], v11 offset:4992
  v_mul_f32 v63, v63, v47
  v_cvt_pk_bf16_f32 v96, v48, v49
  v_cvt_pk_bf16_f32 v97, v50, v51
  v_mfma_f32_32x32x16_bf16 v[208:223], a[12:15], a[168:171], v[208:223]
  ds_read_b64_tr_b16 a[4:5], v11 offset:7168
  ds_read_b64_tr_b16 a[6:7], v11 offset:7936
  v_cvt_pk_bf16_f32 v98, v52, v53
  v_cvt_pk_bf16_f32 v99, v54, v55
  v_cvt_pk_bf16_f32 v100, v56, v57
  v_cvt_pk_bf16_f32 v101, v58, v59
  s_waitcnt lgkmcnt(4)
  v_mfma_f32_32x32x16_bf16 v[128:143], a[16:19], a[172:175], v[128:143]
  ds_read_b64_tr_b16 a[8:9], v11 offset:7232
  ds_read_b64_tr_b16 a[10:11], v11 offset:8000
  v_cvt_pk_bf16_f32 v102, v60, v61
  v_cvt_pk_bf16_f32 v103, v62, v63
  v_cvt_pk_bf16_f32 v104, v64, v65
  v_mfma_f32_32x32x16_bf16 v[144:159], a[20:23], a[172:175], v[144:159]
  ds_read_b64_tr_b16 a[12:13], v11 offset:7296
  ds_read_b64_tr_b16 a[14:15], v11 offset:8064
  v_cvt_pk_bf16_f32 v105, v66, v67
  v_cvt_pk_bf16_f32 v106, v68, v69
  v_cvt_pk_bf16_f32 v107, v70, v71
  s_waitcnt lgkmcnt(4)
  v_mfma_f32_32x32x16_bf16 v[160:175], a[0:3], a[172:175], v[160:175]
  s_waitcnt vmcnt(14)
  s_barrier
  ds_read_b64_tr_b16 a[16:17], v9 offset:18432
  ds_read_b64_tr_b16 a[18:19], v9 offset:19200
  v_cvt_pk_bf16_f32 v108, v72, v73
  v_cvt_pk_bf16_f32 v109, v74, v75
  v_mfma_f32_32x32x16_bf16 v[176:191], a[4:7], a[172:175], v[176:191]
  s_add_u32 m0, s48, 6144
  ds_read_b64_tr_b16 a[20:21], v9 offset:18496
  ds_read_b64_tr_b16 a[22:23], v9 offset:19264
  buffer_load_dwordx4 v6, s[16:19], s93 offen offset:0 lds
  v_cvt_pk_bf16_f32 v110, v76, v77
  v_cvt_pk_bf16_f32 v111, v78, v79
  s_waitcnt lgkmcnt(4)
  v_mfma_f32_32x32x16_bf16 v[192:207], a[8:11], a[172:175], v[192:207]
  ds_read_b64_tr_b16 a[0:1], v9 offset:18560
  ds_read_b64_tr_b16 a[2:3], v9 offset:19328
  v_cvt_pk_bf16_f32 v112, v80, v81
  v_cvt_pk_bf16_f32 v113, v82, v83
  v_cvt_pk_bf16_f32 v114, v84, v85
  v_mfma_f32_32x32x16_bf16 v[208:223], a[12:15], a[172:175], v[208:223]
  ds_read_b64_tr_b16 a[4:5], v9 offset:21504
  ds_read_b64_tr_b16 a[6:7], v9 offset:22272
  v_cvt_pk_bf16_f32 v115, v86, v87
  v_cvt_pk_bf16_f32 v116, v88, v89
  v_cvt_pk_bf16_f32 v117, v90, v91
  s_waitcnt lgkmcnt(4)
  v_mfma_f32_32x32x16_bf16 v[128:143], a[16:19], a[176:179], v[128:143]
  s_add_u32 m0, s48, 6144
  ds_read_b64_tr_b16 a[8:9], v9 offset:21568
  ds_read_b64_tr_b16 a[10:11], v9 offset:22336
  buffer_load_dwordx4 v7, s[16:19], s93 offen offset:1024 lds
  v_cvt_pk_bf16_f32 v118, v92, v93
  v_mfma_f32_32x32x16_bf16 v[144:159], a[20:23], a[176:179], v[144:159]
  ds_read_b64_tr_b16 a[12:13], v9 offset:21632
  ds_read_b64_tr_b16 a[14:15], v9 offset:22400
  v_cvt_pk_bf16_f32 v119, v94, v95
  v_add_f32 v24, v64, v65
  v_add_f32 v24, v24, v66
  v_add_f32 v24, v24, v67
  s_waitcnt lgkmcnt(4)
  v_mfma_f32_32x32x16_bf16 v[160:175], a[0:3], a[176:179], v[160:175]
  ds_read_b64_tr_b16 a[16:17], v9 offset:59392
  ds_read_b64_tr_b16 a[18:19], v9 offset:60160
  v_add_f32 v24, v24, v68
  v_add_f32 v24, v24, v69
  v_add_f32 v24, v24, v70
  v_mfma_f32_32x32x16_bf16 v[176:191], a[4:7], a[176:179], v[176:191]
  s_add_u32 m0, s48, 6144
  ds_read_b64_tr_b16 a[20:21], v9 offset:59456
  ds_read_b64_tr_b16 a[22:23], v9 offset:60224
  buffer_load_dwordx4 v8, s[16:19], s93 offen offset:2048 lds
  v_add_f32 v24, v24, v71
  s_waitcnt lgkmcnt(4)
  v_mfma_f32_32x32x16_bf16 v[192:207], a[8:11], a[176:179], v[192:207]
  ds_read_b64_tr_b16 a[0:1], v9 offset:59520
  ds_read_b64_tr_b16 a[2:3], v9 offset:60288
  v_add_f32 v24, v24, v72
  v_add_f32 v24, v24, v73
  v_add_f32 v24, v24, v74
  v_mfma_f32_32x32x16_bf16 v[208:223], a[12:15], a[176:179], v[208:223]
  ds_read_b64_tr_b16 a[4:5], v9 offset:62464
  ds_read_b64_tr_b16 a[6:7], v9 offset:63232
  v_add_f32 v24, v24, v75
  v_add_f32 v24, v24, v76
  v_add_f32 v24, v24, v77
  v_add_f32 v24, v24, v78
  s_waitcnt lgkmcnt(4)
  v_mfma_f32_32x32x16_bf16 v[128:143], a[16:19], a[180:183], v[128:143]
  ds_read_b64_tr_b16 a[8:9], v9 offset:62528
  ds_read_b64_tr_b16 a[10:11], v9 offset:63296
  v_add_f32 v24, v24, v79
  v_add_f32 v25, v80, v81
  v_add_f32 v25, v25, v82
  v_mfma_f32_32x32x16_bf16 v[144:159], a[20:23], a[180:183], v[144:159]
  s_add_u32 m0, s48, 9216
  ds_read_b64_tr_b16 a[12:13], v9 offset:62592
  ds_read_b64_tr_b16 a[14:15], v9 offset:63360
  buffer_load_dwordx4 v6, s[20:23], s93 offen offset:0 lds
  v_add_f32 v25, v25, v83
  s_waitcnt lgkmcnt(4)
  v_mfma_f32_32x32x16_bf16 v[160:175], a[0:3], a[180:183], v[160:175]
  ds_read_b64_tr_b16 a[16:17], v10 offset:34816
  ds_read_b64_tr_b16 a[18:19], v10 offset:35584
  v_add_f32 v25, v25, v84
  v_add_f32 v25, v25, v85
  v_add_f32 v25, v25, v86
  v_mfma_f32_32x32x16_bf16 v[176:191], a[4:7], a[180:183], v[176:191]
  ds_read_b64_tr_b16 a[20:21], v10 offset:34880
  ds_read_b64_tr_b16 a[22:23], v10 offset:35648
  v_add_f32 v25, v25, v87
  v_add_f32 v25, v25, v88
  v_add_f32 v25, v25, v89
  v_add_f32 v25, v25, v90
  s_waitcnt lgkmcnt(4)
  v_mfma_f32_32x32x16_bf16 v[192:207], a[8:11], a[180:183], v[192:207]
  s_add_u32 m0, s48, 9216
  ds_read_b64_tr_b16 a[0:1], v10 offset:34944
  ds_read_b64_tr_b16 a[2:3], v10 offset:35712
  buffer_load_dwordx4 v7, s[20:23], s93 offen offset:1024 lds
  v_add_f32 v25, v25, v91
  v_mfma_f32_32x32x16_bf16 v[208:223], a[12:15], a[180:183], v[208:223]
  ds_read_b64_tr_b16 a[4:5], v10 offset:37888
  ds_read_b64_tr_b16 a[6:7], v10 offset:38656
  v_add_f32 v25, v25, v92
  v_add_f32 v25, v25, v93
  v_add_f32 v25, v25, v94
  s_waitcnt lgkmcnt(4)
  v_mfma_f32_32x32x16_bf16 v[128:143], a[16:19], a[184:187], v[128:143]
  ds_read_b64_tr_b16 a[8:9], v10 offset:37952
  ds_read_b64_tr_b16 a[10:11], v10 offset:38720
  v_add_f32 v25, v25, v95
  v_mfma_f32_32x32x16_bf16 v[32:47], v[104:107], v[96:99], 0
  v_mfma_f32_32x32x16_bf16 v[64:79], v[112:115], v[96:99], 0
  v_mfma_f32_32x32x16_bf16 v[144:159], a[20:23], a[184:187], v[144:159]
  s_add_u32 m0, s48, 9216
  ds_read_b64_tr_b16 a[12:13], v10 offset:38016
  ds_read_b64_tr_b16 a[14:15], v10 offset:38784
  buffer_load_dwordx4 v8, s[20:23], s93 offen offset:2048 lds
  v_mfma_f32_32x32x16_bf16 v[32:47], v[108:111], v[100:103], v[32:47]
  v_mfma_f32_32x32x16_bf16 v[64:79], v[116:119], v[100:103], v[64:79]
  s_waitcnt lgkmcnt(4)
  v_mfma_f32_32x32x16_bf16 v[160:175], a[0:3], a[184:187], v[160:175]
  ds_read_b64_tr_b16 a[16:17], v11 offset:10240
  ds_read_b64_tr_b16 a[18:19], v11 offset:11008
  v_lshlrev_b32 v27, 2, v1
  v_add_u32 v27, s48, v27
  ds_write_b32 v27, v24 offset:36864
  v_mfma_f32_32x32x16_bf16 v[176:191], a[4:7], a[184:187], v[176:191]
  ds_read_b64_tr_b16 a[20:21], v11 offset:10304
  ds_read_b64_tr_b16 a[22:23], v11 offset:11072
  ds_write_b32 v27, v25 offset:37120
  v_and_b32 v26, 31, v1
  v_lshlrev_b32 v26, 4, v26
  s_waitcnt lgkmcnt(6)
  v_mfma_f32_32x32x16_bf16 v[192:207], a[8:11], a[184:187], v[192:207]
  ds_read_b64_tr_b16 a[0:1], v11 offset:10368
  ds_read_b64_tr_b16 a[2:3], v11 offset:11136
  v_add_u32 v26, s48, v26
  v_mfma_f32_32x32x16_bf16 v[208:223], a[12:15], a[184:187], v[208:223]
  ds_read_b64_tr_b16 a[4:5], v11 offset:13312
  ds_read_b64_tr_b16 a[6:7], v11 offset:14080
  s_waitcnt lgkmcnt(5)
  v_mfma_f32_32x32x16_bf16 v[128:143], a[16:19], a[188:191], v[128:143]
  ds_read_b64_tr_b16 a[8:9], v11 offset:13376
  ds_read_b64_tr_b16 a[10:11], v11 offset:14144
  s_lshr_b32 s6, s2, 3
  s_mul_i32 s6, s6, 49152
  s_lshr_b32 s7, s46, 2
  s_lshl_b32 s7, s7, 8
  s_add_u32 s6, s6, s7
  s_cmp_eq_u32 s44, 2
  s_cselect_b32 s6, s6, 1073741824
  v_lshrrev_b32 v244, 1, v1
  v_mul_u32_u24 v244, 3072, v244
  v_and_b32 v245, 1, v1
  v_lshl_add_u32 v244, v245, 7, v244
  v_cmp_gt_u32 s[100:101], 32, v1
  v_mov_b32 v245, 1073741824
  s_nop 0
  v_cndmask_b32 v244, v245, v244, s[100:101]
  buffer_load_dword a120, v244, s[12:15], s6 offen
  v_mfma_f32_32x32x16_bf16 v[144:159], a[20:23], a[188:191], v[144:159]
  ds_read_b64_tr_b16 a[12:13], v11 offset:13440
  ds_read_b64_tr_b16 a[14:15], v11 offset:14208
  s_mov_b64 exec, s[64:65]
  ds_write_b128 v26, v[32:35] offset:32768
  ds_write_b128 v26, v[64:67] offset:34816
  ds_write_b128 v26, v[36:39] offset:33280
  ds_write_b128 v26, v[68:71] offset:35328
  ds_write_b128 v26, v[40:43] offset:33792
  ds_write_b128 v26, v[72:75] offset:35840
  ds_write_b128 v26, v[44:47] offset:34304
  ds_write_b128 v26, v[76:79] offset:36352
  s_mov_b64 exec, -1
  s_waitcnt lgkmcnt(12)
  v_mfma_f32_32x32x16_bf16 v[160:175], a[0:3], a[188:191], v[160:175]
  s_waitcnt vmcnt(7)
  s_barrier
  ds_read_b64_tr_b16 a[16:17], v9 offset:0
  ds_read_b64_tr_b16 a[18:19], v9 offset:768
  v_mfma_f32_32x32x16_bf16 v[176:191], a[4:7], a[188:191], v[176:191]
  s_add_u32 m0, s48, 12288
  ds_read_b64_tr_b16 a[20:21], v9 offset:64
  ds_read_b64_tr_b16 a[22:23], v9 offset:832
  buffer_load_dwordx4 v6, s[16:19], s94 offen offset:0 lds
  s_waitcnt lgkmcnt(12)
  v_mfma_f32_32x32x16_bf16 v[192:207], a[8:11], a[188:191], v[192:207]
  ds_read_b64_tr_b16 a[0:1], v9 offset:128
  ds_read_b64_tr_b16 a[2:3], v9 offset:896
  v_mfma_f32_32x32x16_bf16 v[208:223], a[12:15], a[188:191], v[208:223]
  ds_read_b64_tr_b16 a[4:5], v9 offset:3072
  ds_read_b64_tr_b16 a[6:7], v9 offset:3840
  s_waitcnt lgkmcnt(4)
  v_mfma_f32_32x32x16_bf16 v[128:143], a[16:19], a[192:195], v[128:143]
  s_add_u32 m0, s48, 12288
  ds_read_b64_tr_b16 a[8:9], v9 offset:3136
  ds_read_b64_tr_b16 a[10:11], v9 offset:3904
  buffer_load_dwordx4 v7, s[16:19], s94 offen offset:1024 lds
  v_mfma_f32_32x32x16_bf16 v[144:159], a[20:23], a[192:195], v[144:159]
  ds_read_b64_tr_b16 a[12:13], v9 offset:3200
  ds_read_b64_tr_b16 a[14:15], v9 offset:3968
  s_waitcnt lgkmcnt(4)
  v_mfma_f32_32x32x16_bf16 v[160:175], a[0:3], a[192:195], v[160:175]
  ds_read_b64_tr_b16 a[16:17], v9 offset:40960
  ds_read_b64_tr_b16 a[18:19], v9 offset:41728
  v_mfma_f32_32x32x16_bf16 v[176:191], a[4:7], a[192:195], v[176:191]
  s_add_u32 m0, s48, 12288
  ds_read_b64_tr_b16 a[20:21], v9 offset:41024
  ds_read_b64_tr_b16 a[22:23], v9 offset:41792
  buffer_load_dwordx4 v8, s[16:19], s94 offen offset:2048 lds
  s_barrier
  v_and_b32 v26, 31, v1
  v_lshlrev_b32 v26, 4, v26
  s_waitcnt lgkmcnt(4)
  v_mfma_f32_32x32x16_bf16 v[192:207], a[8:11], a[192:195], v[192:207]
  ds_read_b64_tr_b16 a[0:1], v9 offset:41088
  ds_read_b64_tr_b16 a[2:3], v9 offset:41856
  v_mov_b32 v27, 2048
  v_cndmask_b32 v27, v27, 0, s[64:65]
  v_mfma_f32_32x32x16_bf16 v[208:223], a[12:15], a[192:195], v[208:223]
  ds_read_b64_tr_b16 a[4:5], v9 offset:44032
  ds_read_b64_tr_b16 a[6:7], v9 offset:44800
  v_add_u32 v26, v26, v27
  s_lshl_b32 s49, s44, 9
  v_add_u32 v26, s49, v26
  v_add_u32 v27, 32768, v26
  s_waitcnt lgkmcnt(4)
  v_mfma_f32_32x32x16_bf16 v[128:143], a[16:19], a[196:199], v[128:143]
  ds_read_b64_tr_b16 a[8:9], v9 offset:44096
  ds_read_b64_tr_b16 a[10:11], v9 offset:44864
  v_add_u32 v25, 81920, v27
  ds_read_b128 v[32:35], v27
  ds_read_b128 v[36:39], v27 offset:40960
  v_mfma_f32_32x32x16_bf16 v[144:159], a[20:23], a[196:199], v[144:159]
  s_add_u32 m0, s48, 15360
  ds_read_b64_tr_b16 a[12:13], v9 offset:44160
  ds_read_b64_tr_b16 a[14:15], v9 offset:44928
  buffer_load_dwordx4 v6, s[20:23], s94 offen offset:0 lds
  ds_read_b128 v[40:43], v25
  s_waitcnt lgkmcnt(7)
  v_mfma_f32_32x32x16_bf16 v[160:175], a[0:3], a[196:199], v[160:175]
  ds_read_b64_tr_b16 a[16:17], v10 offset:16384
  ds_read_b64_tr_b16 a[18:19], v10 offset:17152
  ds_read_b128 v[44:47], v25 offset:40960
  v_and_b32 v24, 31, v1
  v_lshlrev_b32 v24, 2, v24
  v_mfma_f32_32x32x16_bf16 v[176:191], a[4:7], a[196:199], v[176:191]
  ds_read_b64_tr_b16 a[20:21], v10 offset:16448
  ds_read_b64_tr_b16 a[22:23], v10 offset:17216
  v_lshrrev_b32 v23, 5, v1
  v_lshl_add_u32 v24, v23, 8, v24
  v_add_u32 v24, 36864, v24
  v_add_u32 v22, 81920, v24
  s_waitcnt lgkmcnt(6)
  v_mfma_f32_32x32x16_bf16 v[192:207], a[8:11], a[196:199], v[192:207]
  s_add_u32 m0, s48, 15360
  ds_read_b64_tr_b16 a[0:1], v10 offset:16512
  ds_read_b64_tr_b16 a[2:3], v10 offset:17280
  buffer_load_dwordx4 v7, s[20:23], s94 offen offset:1024 lds
  v_mfma_f32_32x32x16_bf16 v[208:223], a[12:15], a[196:199], v[208:223]
  ds_read_b64_tr_b16 a[4:5], v10 offset:19456
  ds_read_b64_tr_b16 a[6:7], v10 offset:20224
  ds_read_b32 v48, v24 offset:0
  ds_read_b32 v49, v24 offset:128
  ds_read_b32 v50, v24 offset:40960
  ds_read_b32 v51, v24 offset:41088
  s_waitcnt lgkmcnt(8)
  v_mfma_f32_32x32x16_bf16 v[128:143], a[16:19], a[200:203], v[128:143]
  ds_read_b64_tr_b16 a[8:9], v10 offset:19520
  ds_read_b64_tr_b16 a[10:11], v10 offset:20288
  ds_read_b32 v52, v22 offset:0
  ds_read_b32 v53, v22 offset:128
  v_mfma_f32_32x32x16_bf16 v[144:159], a[20:23], a[200:203], v[144:159]
  s_add_u32 m0, s48, 15360
  ds_read_b64_tr_b16 a[12:13], v10 offset:19584
  ds_read_b64_tr_b16 a[14:15], v10 offset:20352
  buffer_load_dwordx4 v8, s[20:23], s94 offen offset:2048 lds
  ds_read_b32 v54, v22 offset:40960
  ds_read_b32 v55, v22 offset:41088
  s_waitcnt lgkmcnt(12)
  v_mfma_f32_32x32x16_bf16 v[160:175], a[0:3], a[200:203], v[160:175]
  ds_read_b64_tr_b16 a[16:17], v10 offset:57344
  ds_read_b64_tr_b16 a[18:19], v10 offset:58112
  s_lshl_b32 s49, s46, 4
  s_add_u32 s49, s49, s45
  v_mfma_f32_32x32x16_bf16 v[176:191], a[4:7], a[200:203], v[176:191]
  ds_read_b64_tr_b16 a[20:21], v10 offset:57408
  ds_read_b64_tr_b16 a[22:23], v10 offset:58176
  s_mul_i32 s49, s49, 4608
  s_add_u32 s49, s49, 65536
  v_and_b32 v22, 31, v1
  v_and_b32 v24, 3, v22
  s_waitcnt lgkmcnt(6)
  v_mfma_f32_32x32x16_bf16 v[192:207], a[8:11], a[200:203], v[192:207]
  ds_read_b64_tr_b16 a[0:1], v10 offset:57472
  ds_read_b64_tr_b16 a[2:3], v10 offset:58240
  v_lshrrev_b32 v25, 3, v22
  v_lshl_add_u32 v24, v25, 2, v24
  v_mfma_f32_32x32x16_bf16 v[208:223], a[12:15], a[200:203], v[208:223]
  ds_read_b64_tr_b16 a[4:5], v10 offset:60416
  ds_read_b64_tr_b16 a[6:7], v10 offset:61184
  v_bfe_u32 v25, v22, 2, 1
  v_lshl_add_u32 v24, v25, 5, v24
  v_lshl_add_u32 v24, v23, 4, v24
  v_lshlrev_b32 v24, 2, v24
  s_waitcnt lgkmcnt(4)
  v_mfma_f32_32x32x16_bf16 v[128:143], a[16:19], a[204:207], v[128:143]
  ds_read_b64_tr_b16 a[8:9], v10 offset:60480
  ds_read_b64_tr_b16 a[10:11], v10 offset:61248
  v_mfma_f32_32x32x16_bf16 v[144:159], a[20:23], a[204:207], v[144:159]
  ds_read_b64_tr_b16 a[12:13], v10 offset:60544
  ds_read_b64_tr_b16 a[14:15], v10 offset:61312
  s_waitcnt lgkmcnt(4)
  v_mfma_f32_32x32x16_bf16 v[160:175], a[0:3], a[204:207], v[160:175]
  s_waitcnt vmcnt(7)
  s_barrier
  ds_read_b64_tr_b16 a[16:17], v9 offset:6144
  ds_read_b64_tr_b16 a[18:19], v9 offset:6912
  v_add_f32 v32, v32, v36
  v_add_f32 v40, v40, v44
  v_add_f32 v33, v33, v37
  v_mfma_f32_32x32x16_bf16 v[176:191], a[4:7], a[204:207], v[176:191]
  s_add_u32 m0, s48, 18432
  ds_read_b64_tr_b16 a[20:21], v9 offset:6208
  ds_read_b64_tr_b16 a[22:23], v9 offset:6976
  buffer_load_dwordx4 v6, s[16:19], s95 offen offset:0 lds
  v_add_f32 v41, v41, v45
  s_waitcnt lgkmcnt(4)
  v_mfma_f32_32x32x16_bf16 v[192:207], a[8:11], a[204:207], v[192:207]
  ds_read_b64_tr_b16 a[0:1], v9 offset:6272
  ds_read_b64_tr_b16 a[2:3], v9 offset:7040
  v_add_f32 v34, v34, v38
  v_add_f32 v42, v42, v46
  v_add_f32 v35, v35, v39
  v_mfma_f32_32x32x16_bf16 v[208:223], a[12:15], a[204:207], v[208:223]
  ds_read_b64_tr_b16 a[4:5], v9 offset:9216
  ds_read_b64_tr_b16 a[6:7], v9 offset:9984
  v_add_f32 v43, v43, v47
  v_add_f32 v32, v32, v40
  v_add_f32 v33, v33, v41
  v_add_f32 v34, v34, v42
  s_waitcnt lgkmcnt(4)
  v_mfma_f32_32x32x16_bf16 v[128:143], a[16:19], a[208:211], v[128:143]
  s_add_u32 m0, s48, 18432
  ds_read_b64_tr_b16 a[8:9], v9 offset:9280
  ds_read_b64_tr_b16 a[10:11], v9 offset:10048
  buffer_load_dwordx4 v7, s[16:19], s95 offen offset:1024 lds
  v_mfma_f32_32x32x16_bf16 v[144:159], a[20:23], a[208:211], v[144:159]
  ds_read_b64_tr_b16 a[12:13], v9 offset:9344
  ds_read_b64_tr_b16 a[14:15], v9 offset:10112
  v_add_f32 v35, v35, v43
  buffer_store_dwordx4 v[32:35], v26, s[24:27], s49 offen sc1
  v_add_f32 v48, v48, v52
  v_add_f32 v49, v49, v53
  s_waitcnt lgkmcnt(4)
  v_mfma_f32_32x32x16_bf16 v[160:175], a[0:3], a[208:211], v[160:175]
  ds_read_b64_tr_b16 a[16:17], v9 offset:47104
  ds_read_b64_tr_b16 a[18:19], v9 offset:47872
  v_add_f32 v50, v50, v54
  v_add_f32 v51, v51, v55
  v_add_f32 v48, v48, v49
  v_mfma_f32_32x32x16_bf16 v[176:191], a[4:7], a[208:211], v[176:191]
  s_add_u32 m0, s48, 18432
  ds_read_b64_tr_b16 a[20:21], v9 offset:47168
  ds_read_b64_tr_b16 a[22:23], v9 offset:47936
  buffer_load_dwordx4 v8, s[16:19], s95 offen offset:2048 lds
  v_add_f32 v50, v50, v51
  s_waitcnt lgkmcnt(4)
  v_mfma_f32_32x32x16_bf16 v[192:207], a[8:11], a[208:211], v[192:207]
  ds_read_b64_tr_b16 a[0:1], v9 offset:47232
  ds_read_b64_tr_b16 a[2:3], v9 offset:48000
  v_add_f32 v48, v48, v50
  s_cmp_eq_u32 s44, 0
  s_cselect_b32 s50, 4096, 1073741824
  v_mfma_f32_32x32x16_bf16 v[208:223], a[12:15], a[208:211], v[208:223]
  ds_read_b64_tr_b16 a[4:5], v9 offset:50176
  ds_read_b64_tr_b16 a[6:7], v9 offset:50944
  s_add_u32 s49, s49, s50
  buffer_store_dword v48, v24, s[24:27], s49 offen sc1
  s_waitcnt lgkmcnt(4)
  v_mfma_f32_32x32x16_bf16 v[128:143], a[16:19], a[212:215], v[128:143]
  ds_read_b64_tr_b16 a[8:9], v9 offset:50240
  ds_read_b64_tr_b16 a[10:11], v9 offset:51008
  v_mfma_f32_32x32x16_bf16 v[144:159], a[20:23], a[212:215], v[144:159]
  s_add_u32 m0, s48, 21504
  ds_read_b64_tr_b16 a[12:13], v9 offset:50304
  ds_read_b64_tr_b16 a[14:15], v9 offset:51072
  buffer_load_dwordx4 v6, s[20:23], s95 offen offset:0 lds
  s_waitcnt lgkmcnt(4)
  v_mfma_f32_32x32x16_bf16 v[160:175], a[0:3], a[212:215], v[160:175]
  ds_read_b64_tr_b16 a[16:17], v10 offset:22528
  ds_read_b64_tr_b16 a[18:19], v10 offset:23296
  v_mfma_f32_32x32x16_bf16 v[176:191], a[4:7], a[212:215], v[176:191]
  ds_read_b64_tr_b16 a[20:21], v10 offset:22592
  ds_read_b64_tr_b16 a[22:23], v10 offset:23360
  s_waitcnt lgkmcnt(4)
  v_mfma_f32_32x32x16_bf16 v[192:207], a[8:11], a[212:215], v[192:207]
  s_add_u32 m0, s48, 21504
  ds_read_b64_tr_b16 a[0:1], v10 offset:22656
  ds_read_b64_tr_b16 a[2:3], v10 offset:23424
  buffer_load_dwordx4 v7, s[20:23], s95 offen offset:1024 lds
  s_barrier
  s_add_u32 m0, s63, 32768
  s_lshl4_add_u32 s98, s30, s61
  buffer_load_dwordx4 v12, s[32:35], s98 offen lds
  v_mfma_f32_32x32x16_bf16 v[208:223], a[12:15], a[212:215], v[208:223]
  ds_read_b64_tr_b16 a[4:5], v10 offset:25600
  ds_read_b64_tr_b16 a[6:7], v10 offset:26368
  s_waitcnt lgkmcnt(4)
  v_mfma_f32_32x32x16_bf16 v[128:143], a[16:19], a[216:219], v[128:143]
  ds_read_b64_tr_b16 a[8:9], v10 offset:25664
  ds_read_b64_tr_b16 a[10:11], v10 offset:26432
  v_mfma_f32_32x32x16_bf16 v[144:159], a[20:23], a[216:219], v[144:159]
  s_add_u32 m0, s48, 21504
  ds_read_b64_tr_b16 a[12:13], v10 offset:25728
  ds_read_b64_tr_b16 a[14:15], v10 offset:26496
  buffer_load_dwordx4 v8, s[20:23], s95 offen offset:2048 lds
  s_waitcnt lgkmcnt(4)
  v_mfma_f32_32x32x16_bf16 v[160:175], a[0:3], a[216:219], v[160:175]
  ds_read_b64_tr_b16 a[16:17], v10 offset:63488
  ds_read_b64_tr_b16 a[18:19], v10 offset:64256
  s_add_u32 m0, s63, 34816
  s_lshl4_add_u32 s98, s30, s61
  buffer_load_dwordx4 v227, s[32:35], s98 offen lds
  v_mfma_f32_32x32x16_bf16 v[176:191], a[4:7], a[216:219], v[176:191]
  ds_read_b64_tr_b16 a[20:21], v10 offset:63552
  ds_read_b64_tr_b16 a[22:23], v10 offset:64320
  s_waitcnt lgkmcnt(4)
  v_mfma_f32_32x32x16_bf16 v[192:207], a[8:11], a[216:219], v[192:207]
  ds_read_b64_tr_b16 a[0:1], v10 offset:63616
  ds_read_b64_tr_b16 a[2:3], v10 offset:64384
  v_mfma_f32_32x32x16_bf16 v[208:223], a[12:15], a[216:219], v[208:223]
  ds_read_b64_tr_b16 a[4:5], v11 offset:1024
  ds_read_b64_tr_b16 a[6:7], v11 offset:1792
  s_add_u32 m0, s63, 36864
  s_lshl4_add_u32 s98, s30, s61
  buffer_load_dwordx4 v228, s[32:35], s98 offen lds
  s_waitcnt lgkmcnt(4)
  v_mfma_f32_32x32x16_bf16 v[128:143], a[16:19], a[220:223], v[128:143]
  ds_read_b64_tr_b16 a[8:9], v11 offset:1088
  ds_read_b64_tr_b16 a[10:11], v11 offset:1856
  v_mfma_f32_32x32x16_bf16 v[144:159], a[20:23], a[220:223], v[144:159]
  ds_read_b64_tr_b16 a[12:13], v11 offset:1152
  ds_read_b64_tr_b16 a[14:15], v11 offset:1920
  s_waitcnt lgkmcnt(4)
  v_mfma_f32_32x32x16_bf16 v[160:175], a[0:3], a[220:223], v[160:175]
  s_waitcnt vmcnt(11)
  s_barrier
  ds_read_b64_tr_b16 a[16:17], v9 offset:12288
  ds_read_b64_tr_b16 a[18:19], v9 offset:13056
  s_add_u32 m0, s63, 38912
  s_lshl4_add_u32 s98, s30, s61
  buffer_load_dwordx4 v229, s[32:35], s98 offen lds
  v_mfma_f32_32x32x16_bf16 v[176:191], a[4:7], a[220:223], v[176:191]
  ds_read_b64_tr_b16 a[20:21], v9 offset:12352
  ds_read_b64_tr_b16 a[22:23], v9 offset:13120
  s_add_u32 m0, s48, 0
  s_add_u32 s98, s80, 0
  buffer_load_dwordx4 v5, s[12:15], s98 offen lds
  s_waitcnt lgkmcnt(4)
  v_mfma_f32_32x32x16_bf16 v[192:207], a[8:11], a[220:223], v[192:207]
  ds_read_b64_tr_b16 a[0:1], v9 offset:12416
  ds_read_b64_tr_b16 a[2:3], v9 offset:13184
  v_mfma_f32_32x32x16_bf16 v[208:223], a[12:15], a[220:223], v[208:223]
  ds_read_b64_tr_b16 a[4:5], v9 offset:15360
  ds_read_b64_tr_b16 a[6:7], v9 offset:16128
  s_waitcnt lgkmcnt(4)
  v_mfma_f32_32x32x16_bf16 v[128:143], a[16:19], a[224:227], v[128:143]
  ds_read_b64_tr_b16 a[8:9], v9 offset:15424
  ds_read_b64_tr_b16 a[10:11], v9 offset:16192
  s_add_u32 m0, s48, 1024
  s_add_u32 s98, s81, 0
  buffer_load_dwordx4 v5, s[12:15], s98 offen lds
  s_add_u32 m0, s63, 73728
  s_lshl4_add_u32 s98, s31, s61
  buffer_load_dwordx4 v12, s[32:35], s98 offen lds
  v_mfma_f32_32x32x16_bf16 v[144:159], a[20:23], a[224:227], v[144:159]
  ds_read_b64_tr_b16 a[12:13], v9 offset:15488
  ds_read_b64_tr_b16 a[14:15], v9 offset:16256
  s_waitcnt lgkmcnt(4)
  v_mfma_f32_32x32x16_bf16 v[160:175], a[0:3], a[224:227], v[160:175]
  ds_read_b64_tr_b16 a[16:17], v9 offset:53248
  ds_read_b64_tr_b16 a[18:19], v9 offset:54016
  v_mfma_f32_32x32x16_bf16 v[176:191], a[4:7], a[224:227], v[176:191]
  ds_read_b64_tr_b16 a[20:21], v9 offset:53312
  ds_read_b64_tr_b16 a[22:23], v9 offset:54080
  s_add_u32 m0, s48, 2048
  s_add_u32 s98, s82, 0
  buffer_load_dwordx4 v5, s[12:15], s98 offen lds
  s_waitcnt lgkmcnt(4)
  v_mfma_f32_32x32x16_bf16 v[192:207], a[8:11], a[224:227], v[192:207]
  ds_read_b64_tr_b16 a[0:1], v9 offset:53376
  ds_read_b64_tr_b16 a[2:3], v9 offset:54144
  s_add_u32 m0, s63, 75776
  s_lshl4_add_u32 s98, s31, s61
  buffer_load_dwordx4 v227, s[32:35], s98 offen lds
  v_mfma_f32_32x32x16_bf16 v[208:223], a[12:15], a[224:227], v[208:223]
  ds_read_b64_tr_b16 a[4:5], v9 offset:56320
  ds_read_b64_tr_b16 a[6:7], v9 offset:57088
  s_waitcnt lgkmcnt(4)
  v_mfma_f32_32x32x16_bf16 v[128:143], a[16:19], a[228:231], v[128:143]
  ds_read_b64_tr_b16 a[8:9], v9 offset:56384
  ds_read_b64_tr_b16 a[10:11], v9 offset:57152
  s_add_u32 m0, s48, 3072
  s_add_u32 s98, s83, 0
  buffer_load_dwordx4 v5, s[12:15], s98 offen lds
  v_mfma_f32_32x32x16_bf16 v[144:159], a[20:23], a[228:231], v[144:159]
  ds_read_b64_tr_b16 a[12:13], v9 offset:56448
  ds_read_b64_tr_b16 a[14:15], v9 offset:57216
  s_add_u32 m0, s63, 77824
  s_lshl4_add_u32 s98, s31, s61
  buffer_load_dwordx4 v228, s[32:35], s98 offen lds
  s_waitcnt lgkmcnt(4)
  v_mfma_f32_32x32x16_bf16 v[160:175], a[0:3], a[228:231], v[160:175]
  ds_read_b64_tr_b16 a[16:17], v10 offset:28672
  ds_read_b64_tr_b16 a[18:19], v10 offset:29440
  v_mfma_f32_32x32x16_bf16 v[176:191], a[4:7], a[228:231], v[176:191]
  ds_read_b64_tr_b16 a[20:21], v10 offset:28736
  ds_read_b64_tr_b16 a[22:23], v10 offset:29504
  s_add_u32 m0, s48, 4096
  s_add_u32 s98, s84, 0
  buffer_load_dwordx4 v5, s[12:15], s98 offen lds
  s_waitcnt lgkmcnt(4)
  v_mfma_f32_32x32x16_bf16 v[192:207], a[8:11], a[228:231], v[192:207]
  ds_read_b64_tr_b16 a[0:1], v10 offset:28800
  ds_read_b64_tr_b16 a[2:3], v10 offset:29568
  s_add_u32 m0, s63, 79872
  s_lshl4_add_u32 s98, s31, s61
  buffer_load_dwordx4 v229, s[32:35], s98 offen lds
  v_mfma_f32_32x32x16_bf16 v[208:223], a[12:15], a[228:231], v[208:223]
  ds_read_b64_tr_b16 a[4:5], v10 offset:31744
  ds_read_b64_tr_b16 a[6:7], v10 offset:32512
  s_waitcnt lgkmcnt(4)
  v_mfma_f32_32x32x16_bf16 v[128:143], a[16:19], a[232:235], v[128:143]
  ds_read_b64_tr_b16 a[8:9], v10 offset:31808
  ds_read_b64_tr_b16 a[10:11], v10 offset:32576
  s_add_u32 m0, s48, 5120
  s_add_u32 s98, s85, 0
  buffer_load_dwordx4 v5, s[12:15], s98 offen lds
  v_mfma_f32_32x32x16_bf16 v[144:159], a[20:23], a[232:235], v[144:159]
  ds_read_b64_tr_b16 a[12:13], v10 offset:31872
  ds_read_b64_tr_b16 a[14:15], v10 offset:32640
  s_waitcnt lgkmcnt(4)
  v_mfma_f32_32x32x16_bf16 v[160:175], a[0:3], a[232:235], v[160:175]
  ds_read_b64_tr_b16 a[16:17], v11 offset:4096
  ds_read_b64_tr_b16 a[18:19], v11 offset:4864
  v_mfma_f32_32x32x16_bf16 v[176:191], a[4:7], a[232:235], v[176:191]
  ds_read_b64_tr_b16 a[20:21], v11 offset:4160
  ds_read_b64_tr_b16 a[22:23], v11 offset:4928
  s_waitcnt lgkmcnt(4)
  v_mfma_f32_32x32x16_bf16 v[192:207], a[8:11], a[232:235], v[192:207]
  ds_read_b64_tr_b16 a[0:1], v11 offset:4224
  ds_read_b64_tr_b16 a[2:3], v11 offset:4992
  v_mfma_f32_32x32x16_bf16 v[208:223], a[12:15], a[232:235], v[208:223]
  ds_read_b64_tr_b16 a[4:5], v11 offset:7168
  ds_read_b64_tr_b16 a[6:7], v11 offset:7936
  s_waitcnt lgkmcnt(4)
  v_mfma_f32_32x32x16_bf16 v[128:143], a[16:19], a[236:239], v[128:143]
  ds_read_b64_tr_b16 a[8:9], v11 offset:7232
  ds_read_b64_tr_b16 a[10:11], v11 offset:8000
  v_mfma_f32_32x32x16_bf16 v[144:159], a[20:23], a[236:239], v[144:159]
  ds_read_b64_tr_b16 a[12:13], v11 offset:7296
  ds_read_b64_tr_b16 a[14:15], v11 offset:8064
  s_waitcnt lgkmcnt(4)
  v_mfma_f32_32x32x16_bf16 v[160:175], a[0:3], a[236:239], v[160:175]
  s_waitcnt vmcnt(13)
  s_barrier
  ds_read_b64_tr_b16 a[16:17], v9 offset:18432
  ds_read_b64_tr_b16 a[18:19], v9 offset:19200
  v_mfma_f32_32x32x16_bf16 v[176:191], a[4:7], a[236:239], v[176:191]
  ds_read_b64_tr_b16 a[20:21], v9 offset:18496
  ds_read_b64_tr_b16 a[22:23], v9 offset:19264
  s_add_u32 m0, s48, 6144
  s_add_u32 s98, s86, 0
  buffer_load_dwordx4 v5, s[12:15], s98 offen lds
  s_waitcnt lgkmcnt(4)
  v_mfma_f32_32x32x16_bf16 v[192:207], a[8:11], a[236:239], v[192:207]
  ds_read_b64_tr_b16 a[0:1], v9 offset:18560
  ds_read_b64_tr_b16 a[2:3], v9 offset:19328
  v_mfma_f32_32x32x16_bf16 v[208:223], a[12:15], a[236:239], v[208:223]
  ds_read_b64_tr_b16 a[4:5], v9 offset:21504
  ds_read_b64_tr_b16 a[6:7], v9 offset:22272
  s_waitcnt lgkmcnt(4)
  v_mfma_f32_32x32x16_bf16 v[128:143], a[16:19], a[240:243], v[128:143]
  ds_read_b64_tr_b16 a[8:9], v9 offset:21568
  ds_read_b64_tr_b16 a[10:11], v9 offset:22336
  v_mfma_f32_32x32x16_bf16 v[144:159], a[20:23], a[240:243], v[144:159]
  ds_read_b64_tr_b16 a[12:13], v9 offset:21632
  ds_read_b64_tr_b16 a[14:15], v9 offset:22400
  s_add_u32 m0, s48, 7168
  s_add_u32 s98, s87, 0
  buffer_load_dwordx4 v5, s[12:15], s98 offen lds
  s_waitcnt lgkmcnt(4)
  v_mfma_f32_32x32x16_bf16 v[160:175], a[0:3], a[240:243], v[160:175]
  ds_read_b64_tr_b16 a[16:17], v9 offset:59392
  ds_read_b64_tr_b16 a[18:19], v9 offset:60160
  s_barrier
  s_lshl_b32 s49, s46, 7
  s_lshl_b32 s50, s45, 2
  s_add_u32 s49, s49, s50
  s_add_u32 s49, s49, 4096
  s_cmp_eq_u32 s44, 0
  s_cselect_b32 s49, s49, 1073741824
  v_mov_b32 v24, s47
  v_cmp_eq_u32 vcc, 0, v1
  v_mov_b32 v25, 1073741824
  s_nop 0
  v_cndmask_b32 v25, v25, 0, vcc
  buffer_store_dword v24, v25, s[24:27], s49 offen sc1
  v_mfma_f32_32x32x16_bf16 v[176:191], a[4:7], a[240:243], v[176:191]
  ds_read_b64_tr_b16 a[20:21], v9 offset:59456
  ds_read_b64_tr_b16 a[22:23], v9 offset:60224
  s_waitcnt lgkmcnt(4)
  v_mfma_f32_32x32x16_bf16 v[192:207], a[8:11], a[240:243], v[192:207]
  ds_read_b64_tr_b16 a[0:1], v9 offset:59520
  ds_read_b64_tr_b16 a[2:3], v9 offset:60288
  v_mfma_f32_32x32x16_bf16 v[208:223], a[12:15], a[240:243], v[208:223]
  ds_read_b64_tr_b16 a[4:5], v9 offset:62464
  ds_read_b64_tr_b16 a[6:7], v9 offset:63232
  s_waitcnt lgkmcnt(4)
  v_mfma_f32_32x32x16_bf16 v[128:143], a[16:19], a[244:247], v[128:143]
  ds_read_b64_tr_b16 a[8:9], v9 offset:62528
  ds_read_b64_tr_b16 a[10:11], v9 offset:63296
  v_mfma_f32_32x32x16_bf16 v[144:159], a[20:23], a[244:247], v[144:159]
  ds_read_b64_tr_b16 a[12:13], v9 offset:62592
  ds_read_b64_tr_b16 a[14:15], v9 offset:63360
  s_waitcnt lgkmcnt(4)
  v_mfma_f32_32x32x16_bf16 v[160:175], a[0:3], a[244:247], v[160:175]
  ds_read_b64_tr_b16 a[16:17], v10 offset:34816
  ds_read_b64_tr_b16 a[18:19], v10 offset:35584
  v_mfma_f32_32x32x16_bf16 v[176:191], a[4:7], a[244:247], v[176:191]
  ds_read_b64_tr_b16 a[20:21], v10 offset:34880
  ds_read_b64_tr_b16 a[22:23], v10 offset:35648
  s_waitcnt lgkmcnt(4)
  v_mfma_f32_32x32x16_bf16 v[192:207], a[8:11], a[244:247], v[192:207]
  ds_read_b64_tr_b16 a[0:1], v10 offset:34944
  ds_read_b64_tr_b16 a[2:3], v10 offset:35712
  v_mfma_f32_32x32x16_bf16 v[208:223], a[12:15], a[244:247], v[208:223]
  ds_read_b64_tr_b16 a[4:5], v10 offset:37888
  ds_read_b64_tr_b16 a[6:7], v10 offset:38656
  s_waitcnt lgkmcnt(4)
  v_mfma_f32_32x32x16_bf16 v[128:143], a[16:19], a[248:251], v[128:143]
  ds_read_b64_tr_b16 a[8:9], v10 offset:37952
  ds_read_b64_tr_b16 a[10:11], v10 offset:38720
  v_mfma_f32_32x32x16_bf16 v[144:159], a[20:23], a[248:251], v[144:159]
  ds_read_b64_tr_b16 a[12:13], v10 offset:38016
  ds_read_b64_tr_b16 a[14:15], v10 offset:38784
  s_waitcnt lgkmcnt(4)
  v_mfma_f32_32x32x16_bf16 v[160:175], a[0:3], a[248:251], v[160:175]
  ds_read_b64_tr_b16 a[16:17], v11 offset:10240
  ds_read_b64_tr_b16 a[18:19], v11 offset:11008
  v_mfma_f32_32x32x16_bf16 v[176:191], a[4:7], a[248:251], v[176:191]
  ds_read_b64_tr_b16 a[20:21], v11 offset:10304
  ds_read_b64_tr_b16 a[22:23], v11 offset:11072
  s_waitcnt lgkmcnt(4)
  v_mfma_f32_32x32x16_bf16 v[192:207], a[8:11], a[248:251], v[192:207]
  ds_read_b64_tr_b16 a[0:1], v11 offset:10368
  ds_read_b64_tr_b16 a[2:3], v11 offset:11136
  v_mfma_f32_32x32x16_bf16 v[208:223], a[12:15], a[248:251], v[208:223]
  ds_read_b64_tr_b16 a[4:5], v11 offset:13312
  ds_read_b64_tr_b16 a[6:7], v11 offset:14080
  s_waitcnt lgkmcnt(4)
  v_mfma_f32_32x32x16_bf16 v[128:143], a[16:19], a[252:255], v[128:143]
  ds_read_b64_tr_b16 a[8:9], v11 offset:13376
  ds_read_b64_tr_b16 a[10:11], v11 offset:14144
  v_mfma_f32_32x32x16_bf16 v[144:159], a[20:23], a[252:255], v[144:159]
  ds_read_b64_tr_b16 a[12:13], v11 offset:13440
  ds_read_b64_tr_b16 a[14:15], v11 offset:14208
  s_waitcnt lgkmcnt(4)
  v_mfma_f32_32x32x16_bf16 v[160:175], a[0:3], a[252:255], v[160:175]
  v_mfma_f32_32x32x16_bf16 v[176:191], a[4:7], a[252:255], v[176:191]
  s_waitcnt lgkmcnt(0)
  v_mfma_f32_32x32x16_bf16 v[192:207], a[8:11], a[252:255], v[192:207]
  v_mfma_f32_32x32x16_bf16 v[208:223], a[12:15], a[252:255], v[208:223]
  buffer_load_dwordx2 v[232:233], v230, s[8:11], s99 offen offset:0
  buffer_load_dwordx2 v[234:235], v230, s[8:11], s99 offen offset:16
  buffer_load_dwordx2 v[236:237], v230, s[8:11], s99 offen offset:32
  buffer_load_dwordx2 v[238:239], v230, s[8:11], s99 offen offset:48
  v_max_f32 v128, 0, v128
  v_max_f32 v129, 0, v129
  s_nop 2
  v_pk_mul_f32 v[176:177], v[176:177], v[16:17] op_sel_hi:[1,0]
  v_max_f32 v130, 0, v130
  v_max_f32 v131, 0, v131
  v_pk_mul_f32 v[178:179], v[178:179], v[16:17] op_sel_hi:[1,0]
  v_max_f32 v132, 0, v132
  v_max_f32 v133, 0, v133
  v_pk_mul_f32 v[180:181], v[180:181], v[16:17] op_sel_hi:[1,0]
  v_max_f32 v134, 0, v134
  v_max_f32 v135, 0, v135
  v_pk_mul_f32 v[182:183], v[182:183], v[16:17] op_sel_hi:[1,0]
  v_max_f32 v136, 0, v136
  v_max_f32 v137, 0, v137
  v_pk_mul_f32 v[184:185], v[184:185], v[16:17] op_sel_hi:[1,0]
  v_max_f32 v138, 0, v138
  v_max_f32 v139, 0, v139
  v_pk_mul_f32 v[186:187], v[186:187], v[16:17] op_sel_hi:[1,0]
  v_max_f32 v140, 0, v140
  v_max_f32 v141, 0, v141
  v_pk_mul_f32 v[188:189], v[188:189], v[16:17] op_sel_hi:[1,0]
  v_max_f32 v142, 0, v142
  v_max_f32 v143, 0, v143
  v_pk_mul_f32 v[190:191], v[190:191], v[16:17] op_sel_hi:[1,0]
  v_pk_mul_f32 v[128:129], v[128:129], v[176:177]
  v_pk_mul_f32 v[130:131], v[130:131], v[178:179]
  v_pk_mul_f32 v[132:133], v[132:133], v[180:181]
  v_pk_mul_f32 v[134:135], v[134:135], v[182:183]
  v_pk_mul_f32 v[136:137], v[136:137], v[184:185]
  v_pk_mul_f32 v[138:139], v[138:139], v[186:187]
  v_pk_mul_f32 v[140:141], v[140:141], v[188:189]
  v_pk_mul_f32 v[142:143], v[142:143], v[190:191]
  v_cvt_pk_bf16_f32 v176, v128, v129
  v_cvt_pk_bf16_f32 v177, v130, v131
  v_cvt_pk_bf16_f32 v178, v132, v133
  v_cvt_pk_bf16_f32 v179, v134, v135
  v_cvt_pk_bf16_f32 v180, v136, v137
  v_cvt_pk_bf16_f32 v181, v138, v139
  v_cvt_pk_bf16_f32 v182, v140, v141
  v_cvt_pk_bf16_f32 v183, v142, v143
  s_mul_i32 s49, s57, 86
  s_add_u32 s50, s53, 0
  s_lshl_b32 s50, s50, 1
  s_add_u32 s49, s49, s50
  s_lshl_b32 s49, s49, 10
  s_add_u32 s49, s49, 4194304
  buffer_store_dwordx4 v[176:179], v13, s[24:27], s49 offen sc1
  buffer_store_dwordx4 v[180:183], v13, s[24:27], s49 offen offset:1024 sc1
  v_max_f32 v144, 0, v144
  v_max_f32 v145, 0, v145
  v_pk_mul_f32 v[192:193], v[192:193], v[16:17] op_sel_hi:[1,0]
  v_max_f32 v146, 0, v146
  v_max_f32 v147, 0, v147
  v_pk_mul_f32 v[194:195], v[194:195], v[16:17] op_sel_hi:[1,0]
  v_max_f32 v148, 0, v148
  v_max_f32 v149, 0, v149
  v_pk_mul_f32 v[196:197], v[196:197], v[16:17] op_sel_hi:[1,0]
  v_max_f32 v150, 0, v150
  v_max_f32 v151, 0, v151
  v_pk_mul_f32 v[198:199], v[198:199], v[16:17] op_sel_hi:[1,0]
  v_max_f32 v152, 0, v152
  v_max_f32 v153, 0, v153
  v_pk_mul_f32 v[200:201], v[200:201], v[16:17] op_sel_hi:[1,0]
  v_max_f32 v154, 0, v154
  v_max_f32 v155, 0, v155
  v_pk_mul_f32 v[202:203], v[202:203], v[16:17] op_sel_hi:[1,0]
  v_max_f32 v156, 0, v156
  v_max_f32 v157, 0, v157
  v_pk_mul_f32 v[204:205], v[204:205], v[16:17] op_sel_hi:[1,0]
  v_max_f32 v158, 0, v158
  v_max_f32 v159, 0, v159
  v_pk_mul_f32 v[206:207], v[206:207], v[16:17] op_sel_hi:[1,0]
  v_pk_mul_f32 v[144:145], v[144:145], v[192:193]
  v_pk_mul_f32 v[146:147], v[146:147], v[194:195]
  v_pk_mul_f32 v[148:149], v[148:149], v[196:197]
  v_pk_mul_f32 v[150:151], v[150:151], v[198:199]
  v_pk_mul_f32 v[152:153], v[152:153], v[200:201]
  v_pk_mul_f32 v[154:155], v[154:155], v[202:203]
  v_pk_mul_f32 v[156:157], v[156:157], v[204:205]
  v_pk_mul_f32 v[158:159], v[158:159], v[206:207]
  v_cvt_pk_bf16_f32 v192, v144, v145
  v_cvt_pk_bf16_f32 v193, v146, v147
  v_cvt_pk_bf16_f32 v194, v148, v149
  v_cvt_pk_bf16_f32 v195, v150, v151
  v_cvt_pk_bf16_f32 v196, v152, v153
  v_cvt_pk_bf16_f32 v197, v154, v155
  v_cvt_pk_bf16_f32 v198, v156, v157
  v_cvt_pk_bf16_f32 v199, v158, v159
  s_mul_i32 s49, s57, 86
  s_add_u32 s50, s53, 1
  s_lshl_b32 s50, s50, 1
  s_add_u32 s49, s49, s50
  s_lshl_b32 s49, s49, 10
  s_add_u32 s49, s49, 4194304
  buffer_store_dwordx4 v[192:195], v13, s[24:27], s49 offen sc1
  buffer_store_dwordx4 v[196:199], v13, s[24:27], s49 offen offset:1024 sc1
  v_max_f32 v160, 0, v160
  v_max_f32 v161, 0, v161
  v_pk_mul_f32 v[208:209], v[208:209], v[16:17] op_sel_hi:[1,0]
  v_max_f32 v162, 0, v162
  v_max_f32 v163, 0, v163
  v_pk_mul_f32 v[210:211], v[210:211], v[16:17] op_sel_hi:[1,0]
  v_max_f32 v164, 0, v164
  v_max_f32 v165, 0, v165
  v_pk_mul_f32 v[212:213], v[212:213], v[16:17] op_sel_hi:[1,0]
  v_max_f32 v166, 0, v166
  v_max_f32 v167, 0, v167
  v_pk_mul_f32 v[214:215], v[214:215], v[16:17] op_sel_hi:[1,0]
  v_max_f32 v168, 0, v168
  v_max_f32 v169, 0, v169
  v_pk_mul_f32 v[216:217], v[216:217], v[16:17] op_sel_hi:[1,0]
  v_max_f32 v170, 0, v170
  v_max_f32 v171, 0, v171
  v_pk_mul_f32 v[218:219], v[218:219], v[16:17] op_sel_hi:[1,0]
  v_max_f32 v172, 0, v172
  v_max_f32 v173, 0, v173
  v_pk_mul_f32 v[220:221], v[220:221], v[16:17] op_sel_hi:[1,0]
  v_max_f32 v174, 0, v174
  v_max_f32 v175, 0, v175
  v_pk_mul_f32 v[222:223], v[222:223], v[16:17] op_sel_hi:[1,0]
  v_pk_mul_f32 v[160:161], v[160:161], v[208:209]
  v_pk_mul_f32 v[162:163], v[162:163], v[210:211]
  v_pk_mul_f32 v[164:165], v[164:165], v[212:213]
  v_pk_mul_f32 v[166:167], v[166:167], v[214:215]
  v_pk_mul_f32 v[168:169], v[168:169], v[216:217]
  v_pk_mul_f32 v[170:171], v[170:171], v[218:219]
  v_pk_mul_f32 v[172:173], v[172:173], v[220:221]
  v_pk_mul_f32 v[174:175], v[174:175], v[222:223]
  v_cvt_pk_bf16_f32 v208, v160, v161
  v_cvt_pk_bf16_f32 v209, v162, v163
  v_cvt_pk_bf16_f32 v210, v164, v165
  v_cvt_pk_bf16_f32 v211, v166, v167
  v_cvt_pk_bf16_f32 v212, v168, v169
  v_cvt_pk_bf16_f32 v213, v170, v171
  v_cvt_pk_bf16_f32 v214, v172, v173
  v_cvt_pk_bf16_f32 v215, v174, v175
  s_mul_i32 s49, s57, 86
  s_add_u32 s50, s53, 2
  s_lshl_b32 s50, s50, 1
  s_add_u32 s49, s49, s50
  s_lshl_b32 s49, s49, 10
  s_add_u32 s49, s49, 4194304
  s_cmp_lt_u32 s54, 3
  s_cselect_b32 s49, 1073741824, s49
  buffer_store_dwordx4 v[208:211], v13, s[24:27], s49 offen sc1
  buffer_store_dwordx4 v[212:215], v13, s[24:27], s49 offen offset:1024 sc1
  v_and_b32 v17, 15, v1
  v_lshrrev_b32 v18, 2, v17
  v_lshrrev_b32 v19, 5, v1
  v_lshl_add_u32 v18, v19, 2, v18
  v_lshlrev_b32 v18, 7, v18
  v_bfe_u32 v19, v1, 4, 1
  v_lshl_add_u32 v18, v19, 5, v18
  v_and_b32 v19, 3, v1
  v_lshl_add_u32 v18, v19, 3, v18
  s_lshr_b32 s49, s44, 1
  s_mul_i32 s50, s49, 81920
  v_add_u32 v18, s50, v18
  v_bfe_u32 v19, v17, 3, 1
  v_xor_b32 v19, s49, v19
  v_lshl_add_u32 v6, v19, 6, v18
  v_add_u32 v7, 65536, v6
  v_xor_b32 v19, 1, v19
  v_lshl_add_u32 v8, v19, 6, v18
  v_add_u32 v9, 65536, v8
  s_waitcnt vmcnt(11)
  s_barrier
  ds_read_b64_tr_b16 a[0:1], v2 offset:0
  ds_read_b64_tr_b16 a[2:3], v2 offset:256
  ds_read_b64_tr_b16 a[4:5], v2 offset:40960
  ds_read_b64_tr_b16 a[6:7], v2 offset:41216
  ds_read_b64_tr_b16 a[8:9], v3 offset:16384
  ds_read_b64_tr_b16 a[10:11], v3 offset:16640
  ds_read_b64_tr_b16 a[12:13], v3 offset:57344
  ds_read_b64_tr_b16 a[14:15], v3 offset:57600
  s_waitcnt lgkmcnt(4)
  v_mfma_f32_32x32x16_bf16 v[32:47], a[0:3], a[128:131], 0
  ds_read_b64_tr_b16 a[16:17], v2 offset:1024
  ds_read_b64_tr_b16 a[18:19], v2 offset:1280
  s_add_u32 m0, s63, 8192
  s_lshl4_add_u32 s98, s70, s61
  buffer_load_dwordx4 v12, s[32:35], s98 offen lds
  v_mfma_f32_32x32x16_bf16 v[32:47], a[4:7], a[132:135], v[32:47]
  ds_read_b64_tr_b16 a[20:21], v2 offset:41984
  ds_read_b64_tr_b16 a[22:23], v2 offset:42240
  s_waitcnt lgkmcnt(4)
  v_mfma_f32_32x32x16_bf16 v[32:47], a[8:11], a[136:139], v[32:47]
  ds_read_b64_tr_b16 a[0:1], v3 offset:17408
  ds_read_b64_tr_b16 a[2:3], v3 offset:17664
  v_mfma_f32_32x32x16_bf16 v[32:47], a[12:15], a[140:143], v[32:47]
  ds_read_b64_tr_b16 a[4:5], v3 offset:58368
  ds_read_b64_tr_b16 a[6:7], v3 offset:58624
  s_waitcnt lgkmcnt(4)
  v_mfma_f32_32x32x16_bf16 v[32:47], a[16:19], a[144:147], v[32:47]
  ds_read_b64_tr_b16 a[8:9], v2 offset:2048
  ds_read_b64_tr_b16 a[10:11], v2 offset:2304
  v_mfma_f32_32x32x16_bf16 v[32:47], a[20:23], a[148:151], v[32:47]
  ds_read_b64_tr_b16 a[12:13], v2 offset:43008
  ds_read_b64_tr_b16 a[14:15], v2 offset:43264
  s_waitcnt lgkmcnt(4)
  v_mfma_f32_32x32x16_bf16 v[32:47], a[0:3], a[152:155], v[32:47]
  ds_read_b64_tr_b16 a[16:17], v3 offset:18432
  ds_read_b64_tr_b16 a[18:19], v3 offset:18688
  v_mfma_f32_32x32x16_bf16 v[32:47], a[4:7], a[156:159], v[32:47]
  ds_read_b64_tr_b16 a[20:21], v3 offset:59392
  ds_read_b64_tr_b16 a[22:23], v3 offset:59648
  s_waitcnt lgkmcnt(4)
  v_mfma_f32_32x32x16_bf16 v[32:47], a[8:11], a[160:163], v[32:47]
  ds_read_b64_tr_b16 a[0:1], v2 offset:3072
  ds_read_b64_tr_b16 a[2:3], v2 offset:3328
  s_add_u32 m0, s63, 10240
  s_lshl4_add_u32 s98, s70, s61
  buffer_load_dwordx4 v227, s[32:35], s98 offen lds
  v_mfma_f32_32x32x16_bf16 v[32:47], a[12:15], a[164:167], v[32:47]
  ds_read_b64_tr_b16 a[4:5], v2 offset:44032
  ds_read_b64_tr_b16 a[6:7], v2 offset:44288
  s_waitcnt lgkmcnt(4)
  v_mfma_f32_32x32x16_bf16 v[32:47], a[16:19], a[168:171], v[32:47]
  ds_read_b64_tr_b16 a[8:9], v3 offset:19456
  ds_read_b64_tr_b16 a[10:11], v3 offset:19712
  v_mfma_f32_32x32x16_bf16 v[32:47], a[20:23], a[172:175], v[32:47]
  ds_read_b64_tr_b16 a[12:13], v3 offset:60416
  ds_read_b64_tr_b16 a[14:15], v3 offset:60672
  s_waitcnt lgkmcnt(4)
  v_mfma_f32_32x32x16_bf16 v[32:47], a[0:3], a[176:179], v[32:47]
  ds_read_b64_tr_b16 a[16:17], v2 offset:4096
  ds_read_b64_tr_b16 a[18:19], v2 offset:4352
  v_mfma_f32_32x32x16_bf16 v[32:47], a[4:7], a[180:183], v[32:47]
  ds_read_b64_tr_b16 a[20:21], v2 offset:45056
  ds_read_b64_tr_b16 a[22:23], v2 offset:45312
  s_waitcnt lgkmcnt(4)
  v_mfma_f32_32x32x16_bf16 v[32:47], a[8:11], a[184:187], v[32:47]
  ds_read_b64_tr_b16 a[0:1], v3 offset:20480
  ds_read_b64_tr_b16 a[2:3], v3 offset:20736
  v_mfma_f32_32x32x16_bf16 v[32:47], a[12:15], a[188:191], v[32:47]
  ds_read_b64_tr_b16 a[4:5], v3 offset:61440
  ds_read_b64_tr_b16 a[6:7], v3 offset:61696
  s_waitcnt lgkmcnt(4)
  v_mfma_f32_32x32x16_bf16 v[32:47], a[16:19], a[192:195], v[32:47]
  ds_read_b64_tr_b16 a[8:9], v2 offset:5120
  ds_read_b64_tr_b16 a[10:11], v2 offset:5376
  s_add_u32 m0, s63, 12288
  s_lshl4_add_u32 s98, s70, s61
  buffer_load_dwordx4 v228, s[32:35], s98 offen lds
  v_mfma_f32_32x32x16_bf16 v[32:47], a[20:23], a[196:199], v[32:47]
  ds_read_b64_tr_b16 a[12:13], v2 offset:46080
  ds_read_b64_tr_b16 a[14:15], v2 offset:46336
  s_waitcnt lgkmcnt(4)
  v_mfma_f32_32x32x16_bf16 v[32:47], a[0:3], a[200:203], v[32:47]
  ds_read_b64_tr_b16 a[16:17], v3 offset:21504
  ds_read_b64_tr_b16 a[18:19], v3 offset:21760
  v_mfma_f32_32x32x16_bf16 v[32:47], a[4:7], a[204:207], v[32:47]
  ds_read_b64_tr_b16 a[20:21], v3 offset:62464
  ds_read_b64_tr_b16 a[22:23], v3 offset:62720
  s_waitcnt lgkmcnt(4)
  v_mfma_f32_32x32x16_bf16 v[32:47], a[8:11], a[208:211], v[32:47]
  ds_read_b64_tr_b16 a[0:1], v2 offset:6144
  ds_read_b64_tr_b16 a[2:3], v2 offset:6400
  v_mfma_f32_32x32x16_bf16 v[32:47], a[12:15], a[212:215], v[32:47]
  ds_read_b64_tr_b16 a[4:5], v2 offset:47104
  ds_read_b64_tr_b16 a[6:7], v2 offset:47360
  s_waitcnt lgkmcnt(4)
  v_mfma_f32_32x32x16_bf16 v[32:47], a[16:19], a[216:219], v[32:47]
  ds_read_b64_tr_b16 a[8:9], v3 offset:22528
  ds_read_b64_tr_b16 a[10:11], v3 offset:22784
  v_mfma_f32_32x32x16_bf16 v[32:47], a[20:23], a[220:223], v[32:47]
  ds_read_b64_tr_b16 a[12:13], v3 offset:63488
  ds_read_b64_tr_b16 a[14:15], v3 offset:63744
  s_waitcnt lgkmcnt(4)
  v_mfma_f32_32x32x16_bf16 v[32:47], a[0:3], a[224:227], v[32:47]
  ds_read_b64_tr_b16 a[16:17], v2 offset:7168
  ds_read_b64_tr_b16 a[18:19], v2 offset:7424
  s_add_u32 m0, s63, 14336
  s_lshl4_add_u32 s98, s70, s61
  buffer_load_dwordx4 v229, s[32:35], s98 offen lds
  s_lshl_b32 s49, s46, 7
  s_add_u32 s49, s49, 4096
  v_and_b32 v24, 15, v1
  v_lshlrev_b32 v24, 2, v24
  buffer_load_dword v30, v24, s[24:27], s49 offen sc1
  v_mfma_f32_32x32x16_bf16 v[32:47], a[4:7], a[228:231], v[32:47]
  ds_read_b64_tr_b16 a[20:21], v2 offset:48128
  ds_read_b64_tr_b16 a[22:23], v2 offset:48384
  s_waitcnt lgkmcnt(4)
  v_mfma_f32_32x32x16_bf16 v[32:47], a[8:11], a[232:235], v[32:47]
  ds_read_b64_tr_b16 a[0:1], v3 offset:23552
  ds_read_b64_tr_b16 a[2:3], v3 offset:23808
  v_mfma_f32_32x32x16_bf16 v[32:47], a[12:15], a[236:239], v[32:47]
  ds_read_b64_tr_b16 a[4:5], v3 offset:64512
  ds_read_b64_tr_b16 a[6:7], v3 offset:64768
  s_waitcnt lgkmcnt(4)
  v_mfma_f32_32x32x16_bf16 v[32:47], a[16:19], a[240:243], v[32:47]
  v_mfma_f32_32x32x16_bf16 v[32:47], a[20:23], a[244:247], v[32:47]
  s_waitcnt lgkmcnt(0)
  v_mfma_f32_32x32x16_bf16 v[32:47], a[0:3], a[248:251], v[32:47]
  v_mfma_f32_32x32x16_bf16 v[32:47], a[4:7], a[252:255], v[32:47]
  s_waitcnt vmcnt(5)
  s_barrier
  s_lshl_b32 s49, s45, 7
  s_lshl_b32 s50, s46, 2
  s_add_u32 s49, s49, s50
  s_add_u32 s49, s49, 8192
  s_cmp_eq_u32 s44, 0
  s_cselect_b32 s49, s49, 1073741824
  v_mov_b32 v24, s47
  v_cmp_eq_u32 vcc, 0, v1
  v_mov_b32 v25, 1073741824
  s_nop 0
  v_cndmask_b32 v25, v25, 0, vcc
  buffer_store_dword v24, v25, s[24:27], s49 offen sc1
  s_waitcnt vmcnt(1)
  v_cmp_ne_u32 vcc, s47, v30
  s_lshl_b32 s49, s46, 7
  s_add_u32 s49, s49, 4096
  v_and_b32 v24, 15, v1
  v_lshlrev_b32 v24, 2, v24
  s_mov_b32 s68, 1000000
  s_cbranch_vccz L_poll1_done
L_poll1:
  buffer_load_dword v30, v24, s[24:27], s49 offen sc1
  s_waitcnt vmcnt(0)
  v_cmp_ne_u32 vcc, s47, v30
  s_nop 4
  s_cbranch_vccz L_poll1_done
  s_sub_u32 s68, s68, 1
  s_cmp_eq_u32 s68, 0
  s_cbranch_scc1 L_poll1_done
  s_sleep 1
  s_branch L_poll1
L_poll1_done:
  v_and_b32 v26, 31, v1
  v_lshlrev_b32 v26, 4, v26
  v_mov_b32 v27, 2048
  v_cndmask_b32 v27, v27, 0, s[64:65]
  v_add_u32 v26, v26, v27
  s_lshl_b32 s49, s44, 9
  v_add_u32 v28, s49, v26
  v_lshlrev_b32 v29, 2, v1
  v_add_u32 v29, 4096, v29
  s_lshl_b32 s49, s46, 4
  s_mul_i32 s100, s49, 4608
  s_add_u32 s100, s100, 65536
  s_mul_i32 s49, s44, 18432
  s_add_u32 s68, s100, s49
  s_mov_b32 s6, s100
  s_add_u32 s7, s100, 73728
  s_and_b32 s49, s45, 7
  s_lshl_b32 s49, s49, 1
  s_lshr_b32 s50, s45, 3
  s_add_u32 s49, s49, s50
  s_mul_i32 s49, s49, 4608
  s_add_u32 s100, s100, s49
  v_cvt_pk_bf16_f32 v64, v32, v33
  v_cvt_pk_bf16_f32 v65, v34, v35
  v_cvt_pk_bf16_f32 v66, v36, v37
  v_cvt_pk_bf16_f32 v67, v38, v39
  v_cvt_pk_bf16_f32 v68, v40, v41
  v_cvt_pk_bf16_f32 v69, v42, v43
  buffer_load_dword v192, v29, s[24:27], s68 offen sc1
  s_add_u32 s68, s68, 4608
  v_cvt_pk_bf16_f32 v70, v44, v45
  v_cvt_pk_bf16_f32 v71, v46, v47
  v_mfma_f32_32x32x16_bf16 v[48:63], a[40:43], v[64:67], 0
  s_nop 0
  v_mfma_f32_32x32x16_bf16 v[48:63], a[44:47], v[68:71], v[48:63]
  s_nop 11
  v_max3_f32 v18, v48, v49, v50
  v_min3_f32 v20, v48, v49, v50
  buffer_load_dword v193, v29, s[24:27], s68 offen sc1
  s_add_u32 s68, s68, 4608
  v_max3_f32 v18, v18, v51, v52
  v_min3_f32 v20, v20, v51, v52
  v_max3_f32 v18, v18, v53, v54
  v_min3_f32 v20, v20, v53, v54
  v_max3_f32 v18, v18, v55, v56
  v_min3_f32 v20, v20, v55, v56
  buffer_load_dword v194, v29, s[24:27], s68 offen sc1
  s_add_u32 s68, s68, 4608
  v_max3_f32 v18, v18, v57, v58
  v_min3_f32 v20, v20, v57, v58
  v_max3_f32 v18, v18, v59, v60
  v_min3_f32 v20, v20, v59, v60
  v_max3_f32 v18, v18, v61, v62
  v_min3_f32 v20, v20, v61, v62
  buffer_load_dword v195, v29, s[24:27], s68 offen sc1
  v_max_f32 v18, v18, v63
  v_min_f32 v20, v20, v63
  v_mul_f32 v18, v18, v14
  v_mul_f32 v20, v20, v14
  v_pk_fma_f32 v[64:65], v[48:49], v[14:15], v[18:19] op_sel_hi:[1,0,0] neg_lo:[0,0,1] neg_hi:[0,0,1]
  v_pk_fma_f32 v[80:81], v[48:49], v[14:15], v[20:21] op_sel_hi:[1,0,0] neg_lo:[1,0,0] neg_hi:[1,0,0]
  buffer_load_dwordx4 v[128:131], v28, s[24:27], s100 offen sc1
  s_add_u32 s100, s100, 4608
  s_cmp_eq_u32 s100, s7
  s_cselect_b32 s100, s6, s100
  v_pk_fma_f32 v[66:67], v[50:51], v[14:15], v[18:19] op_sel_hi:[1,0,0] neg_lo:[0,0,1] neg_hi:[0,0,1]
  v_pk_fma_f32 v[82:83], v[50:51], v[14:15], v[20:21] op_sel_hi:[1,0,0] neg_lo:[1,0,0] neg_hi:[1,0,0]
  v_pk_fma_f32 v[68:69], v[52:53], v[14:15], v[18:19] op_sel_hi:[1,0,0] neg_lo:[0,0,1] neg_hi:[0,0,1]
  v_pk_fma_f32 v[84:85], v[52:53], v[14:15], v[20:21] op_sel_hi:[1,0,0] neg_lo:[1,0,0] neg_hi:[1,0,0]
  v_pk_fma_f32 v[70:71], v[54:55], v[14:15], v[18:19] op_sel_hi:[1,0,0] neg_lo:[0,0,1] neg_hi:[0,0,1]
  v_pk_fma_f32 v[86:87], v[54:55], v[14:15], v[20:21] op_sel_hi:[1,0,0] neg_lo:[1,0,0] neg_hi:[1,0,0]
  buffer_load_dwordx4 v[132:135], v28, s[24:27], s100 offen sc1
  s_add_u32 s100, s100, 4608
  s_cmp_eq_u32 s100, s7
  s_cselect_b32 s100, s6, s100
  v_pk_fma_f32 v[72:73], v[56:57], v[14:15], v[18:19] op_sel_hi:[1,0,0] neg_lo:[0,0,1] neg_hi:[0,0,1]
  v_pk_fma_f32 v[88:89], v[56:57], v[14:15], v[20:21] op_sel_hi:[1,0,0] neg_lo:[1,0,0] neg_hi:[1,0,0]
  v_pk_fma_f32 v[74:75], v[58:59], v[14:15], v[18:19] op_sel_hi:[1,0,0] neg_lo:[0,0,1] neg_hi:[0,0,1]
  v_pk_fma_f32 v[90:91], v[58:59], v[14:15], v[20:21] op_sel_hi:[1,0,0] neg_lo:[1,0,0] neg_hi:[1,0,0]
  v_pk_fma_f32 v[76:77], v[60:61], v[14:15], v[18:19] op_sel_hi:[1,0,0] neg_lo:[0,0,1] neg_hi:[0,0,1]
  v_pk_fma_f32 v[92:93], v[60:61], v[14:15], v[20:21] op_sel_hi:[1,0,0] neg_lo:[1,0,0] neg_hi:[1,0,0]
  buffer_load_dwordx4 v[136:139], v28, s[24:27], s100 offen sc1
  s_add_u32 s100, s100, 4608
  s_cmp_eq_u32 s100, s7
  s_cselect_b32 s100, s6, s100
  v_pk_fma_f32 v[78:79], v[62:63], v[14:15], v[18:19] op_sel_hi:[1,0,0] neg_lo:[0,0,1] neg_hi:[0,0,1]
  v_pk_fma_f32 v[94:95], v[62:63], v[14:15], v[20:21] op_sel_hi:[1,0,0] neg_lo:[1,0,0] neg_hi:[1,0,0]
  v_exp_f32 v64, v64
  v_exp_f32 v65, v65
  v_exp_f32 v66, v66
  v_exp_f32 v67, v67
  buffer_load_dwordx4 v[140:143], v28, s[24:27], s100 offen sc1
  s_add_u32 s100, s100, 4608
  s_cmp_eq_u32 s100, s7
  s_cselect_b32 s100, s6, s100
  v_exp_f32 v68, v68
  v_exp_f32 v69, v69
  v_exp_f32 v70, v70
  v_exp_f32 v71, v71
  v_exp_f32 v72, v72
  v_exp_f32 v73, v73
  buffer_load_dwordx4 v[144:147], v28, s[24:27], s100 offen sc1
  s_add_u32 s100, s100, 4608
  s_cmp_eq_u32 s100, s7
  s_cselect_b32 s100, s6, s100
  v_exp_f32 v74, v74
  v_exp_f32 v75, v75
  v_exp_f32 v76, v76
  v_exp_f32 v77, v77
  v_exp_f32 v78, v78
  v_exp_f32 v79, v79
  buffer_load_dwordx4 v[148:151], v28, s[24:27], s100 offen sc1
  s_add_u32 s100, s100, 4608
  s_cmp_eq_u32 s100, s7
  s_cselect_b32 s100, s6, s100
  v_exp_f32 v80, v80
  v_exp_f32 v81, v81
  v_exp_f32 v82, v82
  v_exp_f32 v83, v83
  v_exp_f32 v84, v84
  v_exp_f32 v85, v85
  buffer_load_dwordx4 v[152:155], v28, s[24:27], s100 offen sc1
  s_add_u32 s100, s100, 4608
  s_cmp_eq_u32 s100, s7
  s_cselect_b32 s100, s6, s100
  v_exp_f32 v86, v86
  v_exp_f32 v87, v87
  v_exp_f32 v88, v88
  v_exp_f32 v89, v89
  v_exp_f32 v90, v90
  v_exp_f32 v91, v91
  buffer_load_dwordx4 v[156:159], v28, s[24:27], s100 offen sc1
  s_add_u32 s100, s100, 4608
  s_cmp_eq_u32 s100, s7
  s_cselect_b32 s100, s6, s100
  v_exp_f32 v92, v92
  v_exp_f32 v93, v93
  v_exp_f32 v94, v94
  v_exp_f32 v95, v95
  v_pk_add_f32 v[22:23], v[64:65], v[66:67]
  v_pk_add_f32 v[24:25], v[80:81], v[82:83]
  buffer_load_dwordx4 v[160:163], v28, s[24:27], s100 offen sc1
  s_add_u32 s100, s100, 4608
  s_cmp_eq_u32 s100, s7
  s_cselect_b32 s100, s6, s100
  v_pk_add_f32 v[22:23], v[22:23], v[68:69]
  v_pk_add_f32 v[24:25], v[24:25], v[84:85]
  v_pk_add_f32 v[22:23], v[22:23], v[70:71]
  v_pk_add_f32 v[24:25], v[24:25], v[86:87]
  v_pk_add_f32 v[22:23], v[22:23], v[72:73]
  v_pk_add_f32 v[24:25], v[24:25], v[88:89]
  buffer_load_dwordx4 v[164:167], v28, s[24:27], s100 offen sc1
  s_add_u32 s100, s100, 4608
  s_cmp_eq_u32 s100, s7
  s_cselect_b32 s100, s6, s100
  v_pk_add_f32 v[22:23], v[22:23], v[74:75]
  v_pk_add_f32 v[24:25], v[24:25], v[90:91]
  v_pk_add_f32 v[22:23], v[22:23], v[76:77]
  v_pk_add_f32 v[24:25], v[24:25], v[92:93]
  v_pk_add_f32 v[22:23], v[22:23], v[78:79]
  v_pk_add_f32 v[24:25], v[24:25], v[94:95]
  buffer_load_dwordx4 v[168:171], v28, s[24:27], s100 offen sc1
  s_add_u32 s100, s100, 4608
  s_cmp_eq_u32 s100, s7
  s_cselect_b32 s100, s6, s100
  v_add_f32 v22, v22, v23
  v_add_f32 v24, v24, v25
  v_rcp_f32 v22, v22
  v_rcp_f32 v24, v24
  v_pk_mul_f32 v[64:65], v[64:65], v[22:23] op_sel_hi:[1,0]
  v_pk_mul_f32 v[80:81], v[80:81], v[24:25] op_sel_hi:[1,0]
  buffer_load_dwordx4 v[172:175], v28, s[24:27], s100 offen sc1
  s_add_u32 s100, s100, 4608
  s_cmp_eq_u32 s100, s7
  s_cselect_b32 s100, s6, s100
  v_pk_mul_f32 v[66:67], v[66:67], v[22:23] op_sel_hi:[1,0]
  v_pk_mul_f32 v[82:83], v[82:83], v[24:25] op_sel_hi:[1,0]
  v_pk_mul_f32 v[68:69], v[68:69], v[22:23] op_sel_hi:[1,0]
  v_pk_mul_f32 v[84:85], v[84:85], v[24:25] op_sel_hi:[1,0]
  v_pk_mul_f32 v[70:71], v[70:71], v[22:23] op_sel_hi:[1,0]
  v_pk_mul_f32 v[86:87], v[86:87], v[24:25] op_sel_hi:[1,0]
  buffer_load_dwordx4 v[176:179], v28, s[24:27], s100 offen sc1
  s_add_u32 s100, s100, 4608
  s_cmp_eq_u32 s100, s7
  s_cselect_b32 s100, s6, s100
  v_pk_mul_f32 v[72:73], v[72:73], v[22:23] op_sel_hi:[1,0]
  v_pk_mul_f32 v[88:89], v[88:89], v[24:25] op_sel_hi:[1,0]
  v_pk_mul_f32 v[74:75], v[74:75], v[22:23] op_sel_hi:[1,0]
  v_pk_mul_f32 v[90:91], v[90:91], v[24:25] op_sel_hi:[1,0]
  v_pk_mul_f32 v[76:77], v[76:77], v[22:23] op_sel_hi:[1,0]
  v_pk_mul_f32 v[92:93], v[92:93], v[24:25] op_sel_hi:[1,0]
  buffer_load_dwordx4 v[180:183], v28, s[24:27], s100 offen sc1
  s_add_u32 s100, s100, 4608
  s_cmp_eq_u32 s100, s7
  s_cselect_b32 s100, s6, s100
  v_pk_mul_f32 v[78:79], v[78:79], v[22:23] op_sel_hi:[1,0]
  v_pk_mul_f32 v[94:95], v[94:95], v[24:25] op_sel_hi:[1,0]
  v_cvt_pk_bf16_f32 v112, v64, v65
  v_cvt_pk_bf16_f32 v113, v66, v67
  v_cvt_pk_bf16_f32 v114, v68, v69
  v_cvt_pk_bf16_f32 v115, v70, v71
  buffer_load_dwordx4 v[184:187], v28, s[24:27], s100 offen sc1
  s_add_u32 s100, s100, 4608
  s_cmp_eq_u32 s100, s7
  s_cselect_b32 s100, s6, s100
  v_cvt_pk_bf16_f32 v116, v72, v73
  v_cvt_pk_bf16_f32 v117, v74, v75
  v_cvt_pk_bf16_f32 v118, v76, v77
  v_cvt_pk_bf16_f32 v119, v78, v79
  v_cvt_pk_bf16_f32 v120, v80, v81
  v_cvt_pk_bf16_f32 v121, v82, v83
  buffer_load_dwordx4 v[188:191], v28, s[24:27], s100 offen sc1
  v_cvt_pk_bf16_f32 v122, v84, v85
  v_cvt_pk_bf16_f32 v123, v86, v87
  v_cvt_pk_bf16_f32 v124, v88, v89
  v_cvt_pk_bf16_f32 v125, v90, v91
  v_cvt_pk_bf16_f32 v126, v92, v93
  v_cvt_pk_bf16_f32 v127, v94, v95
  s_lshl_b32 s49, s69, 7
  s_add_u32 s49, s49, 8192
  v_and_b32 v24, 15, v1
  v_lshlrev_b32 v24, 2, v24
  buffer_load_dword v30, v24, s[24:27], s49 offen sc1
  s_waitcnt vmcnt(19)
  v_add_f32 v192, v192, v193
  s_waitcnt vmcnt(18)
  v_add_f32 v192, v192, v194
  s_waitcnt vmcnt(17)
  v_add_f32 v192, v192, v195
  s_waitcnt vmcnt(15)
  v_pk_add_f32 v[128:129], v[128:129], v[132:133]
  v_pk_add_f32 v[130:131], v[130:131], v[134:135]
  s_waitcnt vmcnt(14)
  v_pk_add_f32 v[128:129], v[128:129], v[136:137]
  v_pk_add_f32 v[130:131], v[130:131], v[138:139]
  s_waitcnt vmcnt(13)
  v_pk_add_f32 v[128:129], v[128:129], v[140:141]
  v_pk_add_f32 v[130:131], v[130:131], v[142:143]
  s_waitcnt vmcnt(12)
  v_pk_add_f32 v[128:129], v[128:129], v[144:145]
  v_pk_add_f32 v[130:131], v[130:131], v[146:147]
  s_waitcnt vmcnt(11)
  v_pk_add_f32 v[128:129], v[128:129], v[148:149]
  v_pk_add_f32 v[130:131], v[130:131], v[150:151]
  s_waitcnt vmcnt(10)
  v_pk_add_f32 v[128:129], v[128:129], v[152:153]
  v_pk_add_f32 v[130:131], v[130:131], v[154:155]
  s_waitcnt vmcnt(9)
  v_pk_add_f32 v[128:129], v[128:129], v[156:157]
  v_pk_add_f32 v[130:131], v[130:131], v[158:159]
  s_waitcnt vmcnt(8)
  v_pk_add_f32 v[128:129], v[128:129], v[160:161]
  v_pk_add_f32 v[130:131], v[130:131], v[162:163]
  s_add_u32 m0, s63, 16384
  s_lshl4_add_u32 s98, s71, s61
  buffer_load_dwordx4 v12, s[32:35], s98 offen lds
  s_waitcnt vmcnt(8)
  v_pk_add_f32 v[128:129], v[128:129], v[164:165]
  v_pk_add_f32 v[130:131], v[130:131], v[166:167]
  s_add_u32 m0, s63, 18432
  s_lshl4_add_u32 s98, s71, s61
  buffer_load_dwordx4 v227, s[32:35], s98 offen lds
  s_waitcnt vmcnt(8)
  v_pk_add_f32 v[128:129], v[128:129], v[168:169]
  v_pk_add_f32 v[130:131], v[130:131], v[170:171]
  s_add_u32 m0, s63, 20480
  s_lshl4_add_u32 s98, s71, s61
  buffer_load_dwordx4 v228, s[32:35], s98 offen lds
  s_waitcnt vmcnt(8)
  v_pk_add_f32 v[128:129], v[128:129], v[172:173]
  v_pk_add_f32 v[130:131], v[130:131], v[174:175]
  s_add_u32 m0, s63, 22528
  s_lshl4_add_u32 s98, s71, s61
  buffer_load_dwordx4 v229, s[32:35], s98 offen lds
  s_waitcnt vmcnt(8)
  v_pk_add_f32 v[128:129], v[128:129], v[176:177]
  v_pk_add_f32 v[130:131], v[130:131], v[178:179]
  s_add_u32 m0, s63, 49152
  s_lshl4_add_u32 s98, s72, s61
  buffer_load_dwordx4 v12, s[32:35], s98 offen lds
  s_waitcnt vmcnt(8)
  v_pk_add_f32 v[128:129], v[128:129], v[180:181]
  v_pk_add_f32 v[130:131], v[130:131], v[182:183]
  s_add_u32 m0, s63, 51200
  s_lshl4_add_u32 s98, s72, s61
  buffer_load_dwordx4 v227, s[32:35], s98 offen lds
  s_waitcnt vmcnt(8)
  v_pk_add_f32 v[128:129], v[128:129], v[184:185]
  v_pk_add_f32 v[130:131], v[130:131], v[186:187]
  s_waitcnt vmcnt(7)
  v_pk_add_f32 v[128:129], v[128:129], v[188:189]
  v_pk_add_f32 v[130:131], v[130:131], v[190:191]
  v_add_u32 v25, s48, v13
  ds_write_b128 v25, v[128:131] offset:6144
  v_lshlrev_b32 v27, 2, v1
  v_add_u32 v27, s48, v27
  ds_write_b32 v27, v192 offset:7168
  s_waitcnt lgkmcnt(0)
  s_barrier
  s_waitcnt vmcnt(6)
  v_cmp_ne_u32 vcc, s47, v30
  s_lshl_b32 s49, s69, 7
  s_add_u32 s49, s49, 8192
  v_and_b32 v24, 15, v1
  v_lshlrev_b32 v24, 2, v24
  s_mov_b32 s68, 1000000
  s_cbranch_vccz L_poll2_done
L_poll2:
  buffer_load_dword v30, v24, s[24:27], s49 offen sc1
  s_waitcnt vmcnt(0)
  v_cmp_ne_u32 vcc, s47, v30
  s_nop 4
  s_cbranch_vccz L_poll2_done
  s_sub_u32 s68, s68, 1
  s_cmp_eq_u32 s68, 0
  s_cbranch_scc1 L_poll2_done
  s_sleep 1
  s_branch L_poll2
L_poll2_done:
  v_add_u32 v25, 6144, v13
  v_add_u32 v24, 81920, v25
  ds_read_b128 v[32:35], v25
  ds_read_b128 v[36:39], v25 offset:40960
  ds_read_b128 v[40:43], v24
  ds_read_b128 v[44:47], v24 offset:40960
  s_add_u32 s100, s59, s28
  buffer_load_dwordx4 v[128:131], v13, s[24:27], s100 offen offset:0 sc1
  v_lshlrev_b32 v27, 2, v1
  v_add_u32 v27, 7168, v27
  v_add_u32 v26, 81920, v27
  ds_read_b32 v20, v27
  ds_read_b32 v21, v27 offset:40960
  ds_read_b32 v22, v26
  s_add_u32 m0, s63, 53248
  s_lshl4_add_u32 s98, s72, s61
  buffer_load_dwordx4 v228, s[32:35], s98 offen lds
  ds_read_b32 v23, v26 offset:40960
  s_waitcnt lgkmcnt(7)
  v_cvt_pk_bf16_f32 v48, v32, v33
  v_cvt_pk_bf16_f32 v49, v34, v35
  s_waitcnt lgkmcnt(6)
  v_cvt_pk_bf16_f32 v50, v36, v37
  v_cvt_pk_bf16_f32 v51, v38, v39
  s_waitcnt lgkmcnt(5)
  v_cvt_pk_bf16_f32 v52, v40, v41
  buffer_load_dwordx4 v[132:135], v13, s[24:27], s100 offen offset:1024 sc1
  v_cvt_pk_bf16_f32 v53, v42, v43
  s_waitcnt lgkmcnt(4)
  v_cvt_pk_bf16_f32 v54, v44, v45
  v_cvt_pk_bf16_f32 v55, v46, v47
  s_waitcnt lgkmcnt(2)
  v_add_f32 v20, v20, v21
  s_waitcnt lgkmcnt(0)
  v_add_f32 v22, v22, v23
  v_add_f32 v20, v20, v22
  s_add_u32 m0, s63, 55296
  s_lshl4_add_u32 s98, s72, s61
  buffer_load_dwordx4 v229, s[32:35], s98 offen lds
  v_lshlrev_b32 v27, 2, v1
  v_add_u32 v27, s48, v27
  ds_write_b32 v27, v20 offset:7424
  v_lshrrev_b32 v27, 5, v1
  v_lshlrev_b32 v27, 7, v27
  v_add_u32 v27, s48, v27
  buffer_load_dwordx4 v[136:139], v13, s[24:27], s100 offen offset:2048 sc1
  ds_read_b128 v[64:67], v27 offset:7424
  ds_read_b128 v[68:71], v27 offset:7440
  ds_read_b128 v[72:75], v27 offset:7456
  ds_read_b128 v[76:79], v27 offset:7472
  ds_read_b128 v[80:83], v27 offset:7488
  ds_read_b128 v[84:87], v27 offset:7504
  s_add_u32 m0, s63, 57344
  s_lshl4_add_u32 s98, s73, s61
  buffer_load_dwordx4 v12, s[32:35], s98 offen lds
  ds_read_b128 v[88:91], v27 offset:7520
  ds_read_b128 v[92:95], v27 offset:7536
  v_cndmask_b32 v96, 0, v48, s[64:65]
  v_mov_b32 v56, v48
  v_cndmask_b32 v97, 0, v49, s[64:65]
  v_mov_b32 v57, v49
  s_cmp_eq_u32 s28, 40960
  s_cselect_b32 s68, 1073741824, s100
  buffer_load_dwordx4 v[140:143], v13, s[24:27], s68 offen offset:3072 sc1
  v_cndmask_b32 v98, 0, v50, s[64:65]
  v_mov_b32 v58, v50
  v_cndmask_b32 v99, 0, v51, s[64:65]
  v_mov_b32 v59, v51
  v_cndmask_b32 v100, 0, v52, s[64:65]
  v_mov_b32 v60, v52
  s_add_u32 m0, s63, 59392
  s_lshl4_add_u32 s98, s73, s61
  buffer_load_dwordx4 v227, s[32:35], s98 offen lds
  v_cndmask_b32 v101, 0, v53, s[64:65]
  v_mov_b32 v61, v53
  v_cndmask_b32 v102, 0, v54, s[64:65]
  v_mov_b32 v62, v54
  v_cndmask_b32 v103, 0, v55, s[64:65]
  v_mov_b32 v63, v55
  s_add_u32 s100, s59, s29
  buffer_load_dwordx4 v[144:147], v13, s[24:27], s100 offen offset:0 sc1
  v_permlane32_swap_b32 v48, v56
  v_permlane32_swap_b32 v49, v57
  v_permlane32_swap_b32 v50, v58
  v_permlane32_swap_b32 v51, v59
  v_permlane32_swap_b32 v52, v60
  v_permlane32_swap_b32 v53, v61
  s_add_u32 m0, s63, 61440
  s_lshl4_add_u32 s98, s73, s61
  buffer_load_dwordx4 v228, s[32:35], s98 offen lds
  v_permlane32_swap_b32 v54, v62
  v_permlane32_swap_b32 v55, v63
  v_cndmask_b32 v48, v56, v48, s[66:67]
  v_cndmask_b32 v104, 0, v48, s[64:65]
  v_cndmask_b32 v49, v57, v49, s[66:67]
  v_cndmask_b32 v105, 0, v49, s[64:65]
  buffer_load_dwordx4 v[148:151], v13, s[24:27], s100 offen offset:1024 sc1
  v_cndmask_b32 v50, v58, v50, s[66:67]
  v_cndmask_b32 v106, 0, v50, s[64:65]
  v_cndmask_b32 v51, v59, v51, s[66:67]
  v_cndmask_b32 v107, 0, v51, s[64:65]
  v_cndmask_b32 v52, v60, v52, s[66:67]
  v_cndmask_b32 v108, 0, v52, s[64:65]
  s_add_u32 m0, s63, 63488
  s_lshl4_add_u32 s98, s73, s61
  buffer_load_dwordx4 v229, s[32:35], s98 offen lds
  v_cndmask_b32 v53, v61, v53, s[66:67]
  v_cndmask_b32 v109, 0, v53, s[64:65]
  v_cndmask_b32 v54, v62, v54, s[66:67]
  v_cndmask_b32 v110, 0, v54, s[64:65]
  v_cndmask_b32 v55, v63, v55, s[66:67]
  v_cndmask_b32 v111, 0, v55, s[64:65]
  buffer_load_dwordx4 v[152:155], v13, s[24:27], s100 offen offset:2048 sc1
  v_mfma_f32_32x32x16_bf16 v[208:223], v[96:99], v[112:115], 0
  v_mfma_f32_32x32x16_bf16 v[208:223], v[100:103], v[116:119], v[208:223]
  v_mfma_f32_32x32x16_bf16 v[208:223], v[104:107], v[120:123], v[208:223]
  v_mfma_f32_32x32x16_bf16 v[208:223], v[108:111], v[124:127], v[208:223]
  s_waitcnt lgkmcnt(7)
  v_cvt_pk_bf16_f32 v32, v64, v65
  v_cvt_pk_bf16_f32 v33, v66, v67
  s_add_u32 m0, s63, 0
  s_lshl4_add_u32 s98, s74, s61
  buffer_load_dwordx4 v12, s[32:35], s98 offen lds
  s_waitcnt lgkmcnt(6)
  v_cvt_pk_bf16_f32 v34, v68, v69
  v_cvt_pk_bf16_f32 v35, v70, v71
  s_waitcnt lgkmcnt(5)
  v_cvt_pk_bf16_f32 v36, v72, v73
  v_cvt_pk_bf16_f32 v37, v74, v75
  s_waitcnt lgkmcnt(4)
  v_cvt_pk_bf16_f32 v38, v76, v77
  v_cvt_pk_bf16_f32 v39, v78, v79
  s_cmp_eq_u32 s29, 40960
  s_cselect_b32 s68, 1073741824, s100
  buffer_load_dwordx4 v[156:159], v13, s[24:27], s68 offen offset:3072 sc1
  s_waitcnt lgkmcnt(3)
  v_cvt_pk_bf16_f32 v40, v80, v81
  v_cvt_pk_bf16_f32 v41, v82, v83
  s_waitcnt lgkmcnt(2)
  v_cvt_pk_bf16_f32 v42, v84, v85
  v_cvt_pk_bf16_f32 v43, v86, v87
  s_waitcnt lgkmcnt(1)
  v_cvt_pk_bf16_f32 v44, v88, v89
  v_cvt_pk_bf16_f32 v45, v90, v91
  s_add_u32 m0, s63, 2048
  s_lshl4_add_u32 s98, s74, s61
  buffer_load_dwordx4 v227, s[32:35], s98 offen lds
  s_waitcnt lgkmcnt(0)
  v_cvt_pk_bf16_f32 v46, v92, v93
  v_cvt_pk_bf16_f32 v47, v94, v95
  v_mov_b32 v24, 0x358637bd
  v_dot2c_f32_bf16 v24, v32, v112
  v_dot2c_f32_bf16 v24, v33, v113
  v_dot2c_f32_bf16 v24, v34, v114
  s_add_u32 m0, s63, 4096
  s_lshl4_add_u32 s98, s74, s61
  buffer_load_dwordx4 v228, s[32:35], s98 offen lds
  v_dot2c_f32_bf16 v24, v35, v115
  v_dot2c_f32_bf16 v24, v36, v116
  v_dot2c_f32_bf16 v24, v37, v117
  v_dot2c_f32_bf16 v24, v38, v118
  v_dot2c_f32_bf16 v24, v39, v119
  v_dot2c_f32_bf16 v24, v40, v120
  s_add_u32 m0, s63, 40960
  s_lshl4_add_u32 s98, s74, s61
  buffer_load_dwordx4 v229, s[32:35], s98 offen lds
  v_dot2c_f32_bf16 v24, v41, v121
  v_dot2c_f32_bf16 v24, v42, v122
  v_dot2c_f32_bf16 v24, v43, v123
  v_dot2c_f32_bf16 v24, v44, v124
  v_dot2c_f32_bf16 v24, v45, v125
  v_dot2c_f32_bf16 v24, v46, v126
  s_add_u32 m0, s63, 43008
  s_lshl4_add_u32 s98, s75, s61
  buffer_load_dwordx4 v12, s[32:35], s98 offen lds
  v_dot2c_f32_bf16 v24, v47, v127
  s_nop 2
  v_mov_b32 v25, v24
  s_nop 1
  v_permlane32_swap_b32 v24, v25
  v_rcp_f32 v24, v24
  v_rcp_f32 v25, v25
  s_nop 0
  v_pk_mul_f32 v[208:209], v[208:209], v[24:25] op_sel_hi:[1,0]
  s_add_u32 m0, s63, 45056
  s_lshl4_add_u32 s98, s75, s61
  buffer_load_dwordx4 v227, s[32:35], s98 offen lds
  v_pk_mul_f32 v[210:211], v[210:211], v[24:25] op_sel_hi:[1,0]
  v_pk_mul_f32 v[212:213], v[212:213], v[24:25] op_sel_hi:[1,0]
  v_pk_mul_f32 v[214:215], v[214:215], v[24:25] op_sel_hi:[1,0]
  v_pk_mul_f32 v[216:217], v[216:217], v[24:25] op_sel:[0,1] op_sel_hi:[1,1]
  v_pk_mul_f32 v[218:219], v[218:219], v[24:25] op_sel:[0,1] op_sel_hi:[1,1]
  v_pk_mul_f32 v[220:221], v[220:221], v[24:25] op_sel:[0,1] op_sel_hi:[1,1]
  v_pk_mul_f32 v[222:223], v[222:223], v[24:25] op_sel:[0,1] op_sel_hi:[1,1]
  v_cvt_pk_bf16_f32 v80, v208, v209
  v_cvt_pk_bf16_f32 v81, v210, v211
  v_cvt_pk_bf16_f32 v82, v212, v213
  v_cvt_pk_bf16_f32 v83, v214, v215
  v_cvt_pk_bf16_f32 v84, v216, v217
  v_cvt_pk_bf16_f32 v85, v218, v219
  v_cvt_pk_bf16_f32 v86, v220, v221
  v_cvt_pk_bf16_f32 v87, v222, v223
  s_lshl_b32 s49, s57, 5
  s_lshl_b32 s50, s46, 1
  s_add_u32 s49, s49, s50
  s_lshl_b32 s49, s49, 10
  s_add_u32 s49, s49, 2097152
  buffer_store_dwordx4 v[80:83], v13, s[24:27], s49 offen sc1
  buffer_store_dwordx4 v[84:87], v13, s[24:27], s49 offen offset:1024 sc1
  s_barrier
  ds_read_b64_tr_b16 a[0:1], v6 offset:24576
  ds_read_b64_tr_b16 a[2:3], v6 offset:25600
  ds_read_b64_tr_b16 a[4:5], v8 offset:24576
  ds_read_b64_tr_b16 a[6:7], v8 offset:25600
  ds_read_b64_tr_b16 a[8:9], v6 offset:26624
  ds_read_b64_tr_b16 a[10:11], v6 offset:27648
  ds_read_b64_tr_b16 a[12:13], v8 offset:26624
  ds_read_b64_tr_b16 a[14:15], v8 offset:27648
  s_waitcnt vmcnt(21) lgkmcnt(6)
  v_mfma_f32_32x32x16_bf16 v[32:47], a[0:3], v[128:131], 0
  s_add_u32 s100, s59, s30
  buffer_load_dwordx4 v[160:163], v13, s[24:27], s100 offen offset:0 sc1
  ds_read_b64_tr_b16 a[16:17], v6 offset:28672
  ds_read_b64_tr_b16 a[18:19], v6 offset:29696
  ds_read_b64_tr_b16 a[20:21], v8 offset:28672
  ds_read_b64_tr_b16 a[22:23], v8 offset:29696
  s_waitcnt lgkmcnt(8)
  v_mfma_f32_32x32x16_bf16 v[48:63], a[4:7], v[128:131], 0
  s_waitcnt vmcnt(20) lgkmcnt(6)
  v_mfma_f32_32x32x16_bf16 v[32:47], a[8:11], v[132:135], v[32:47]
  buffer_load_dwordx4 v[164:167], v13, s[24:27], s100 offen offset:1024 sc1
  ds_read_b64_tr_b16 a[0:1], v6 offset:30720
  ds_read_b64_tr_b16 a[2:3], v6 offset:31744
  ds_read_b64_tr_b16 a[4:5], v8 offset:30720
  ds_read_b64_tr_b16 a[6:7], v8 offset:31744
  s_waitcnt lgkmcnt(8)
  v_mfma_f32_32x32x16_bf16 v[48:63], a[12:15], v[132:135], v[48:63]
  s_waitcnt vmcnt(19) lgkmcnt(6)
  v_mfma_f32_32x32x16_bf16 v[32:47], a[16:19], v[136:139], v[32:47]
  buffer_load_dwordx4 v[168:171], v13, s[24:27], s100 offen offset:2048 sc1
  s_barrier
  ds_read_b64_tr_b16 a[8:9], v7 offset:0
  ds_read_b64_tr_b16 a[10:11], v7 offset:1024
  ds_read_b64_tr_b16 a[12:13], v9 offset:0
  ds_read_b64_tr_b16 a[14:15], v9 offset:1024
  s_waitcnt lgkmcnt(8)
  v_mfma_f32_32x32x16_bf16 v[48:63], a[20:23], v[136:139], v[48:63]
  s_waitcnt vmcnt(18) lgkmcnt(6)
  v_mfma_f32_32x32x16_bf16 v[32:47], a[0:3], v[140:143], v[32:47]
  s_cmp_eq_u32 s30, 40960
  s_cselect_b32 s68, 1073741824, s100
  buffer_load_dwordx4 v[172:175], v13, s[24:27], s68 offen offset:3072 sc1
  ds_read_b64_tr_b16 a[16:17], v7 offset:2048
  ds_read_b64_tr_b16 a[18:19], v7 offset:3072
  ds_read_b64_tr_b16 a[20:21], v9 offset:2048
  ds_read_b64_tr_b16 a[22:23], v9 offset:3072
  s_waitcnt lgkmcnt(8)
  v_mfma_f32_32x32x16_bf16 v[48:63], a[4:7], v[140:143], v[48:63]
  s_waitcnt vmcnt(17) lgkmcnt(6)
  v_mfma_f32_32x32x16_bf16 v[32:47], a[8:11], v[144:147], v[32:47]
  s_add_u32 s100, s59, s31
  buffer_load_dwordx4 v[176:179], v13, s[24:27], s100 offen offset:0 sc1
  ds_read_b64_tr_b16 a[0:1], v7 offset:4096
  ds_read_b64_tr_b16 a[2:3], v7 offset:5120
  ds_read_b64_tr_b16 a[4:5], v9 offset:4096
  ds_read_b64_tr_b16 a[6:7], v9 offset:5120
  s_waitcnt lgkmcnt(8)
  v_mfma_f32_32x32x16_bf16 v[48:63], a[12:15], v[144:147], v[48:63]
  s_waitcnt vmcnt(16) lgkmcnt(6)
  v_mfma_f32_32x32x16_bf16 v[32:47], a[16:19], v[148:151], v[32:47]
  buffer_load_dwordx4 v[180:183], v13, s[24:27], s100 offen offset:1024 sc1
  ds_read_b64_tr_b16 a[8:9], v7 offset:6144
  ds_read_b64_tr_b16 a[10:11], v7 offset:7168
  ds_read_b64_tr_b16 a[12:13], v9 offset:6144
  ds_read_b64_tr_b16 a[14:15], v9 offset:7168
  s_waitcnt lgkmcnt(8)
  v_mfma_f32_32x32x16_bf16 v[48:63], a[20:23], v[148:151], v[48:63]
  s_waitcnt vmcnt(15) lgkmcnt(6)
  v_mfma_f32_32x32x16_bf16 v[32:47], a[0:3], v[152:155], v[32:47]
  buffer_load_dwordx4 v[184:187], v13, s[24:27], s100 offen offset:2048 sc1
  s_barrier
  ds_read_b64_tr_b16 a[16:17], v6 offset:32768
  ds_read_b64_tr_b16 a[18:19], v6 offset:33792
  ds_read_b64_tr_b16 a[20:21], v8 offset:32768
  ds_read_b64_tr_b16 a[22:23], v8 offset:33792
  s_waitcnt lgkmcnt(8)
  v_mfma_f32_32x32x16_bf16 v[48:63], a[4:7], v[152:155], v[48:63]
  s_add_u32 m0, s63, 24576
  s_lshl4_add_u32 s98, s75, s61
  buffer_load_dwordx4 v228, s[32:35], s98 offen lds
  s_waitcnt vmcnt(15) lgkmcnt(6)
  v_mfma_f32_32x32x16_bf16 v[32:47], a[8:11], v[156:159], v[32:47]
  s_cmp_eq_u32 s31, 40960
  s_cselect_b32 s68, 1073741824, s100
  buffer_load_dwordx4 v[188:191], v13, s[24:27], s68 offen offset:3072 sc1
  ds_read_b64_tr_b16 a[0:1], v6 offset:34816
  ds_read_b64_tr_b16 a[2:3], v6 offset:35840
  ds_read_b64_tr_b16 a[4:5], v8 offset:34816
  ds_read_b64_tr_b16 a[6:7], v8 offset:35840
  s_waitcnt lgkmcnt(8)
  v_mfma_f32_32x32x16_bf16 v[48:63], a[12:15], v[156:159], v[48:63]
  s_add_u32 m0, s63, 26624
  s_lshl4_add_u32 s98, s75, s61
  buffer_load_dwordx4 v229, s[32:35], s98 offen lds
  s_waitcnt vmcnt(9) lgkmcnt(6)
  v_mfma_f32_32x32x16_bf16 v[32:47], a[16:19], v[160:163], v[32:47]
  s_add_u32 s100, s59, s70
  buffer_load_dwordx4 v[128:131], v13, s[24:27], s100 offen offset:0 sc1
  ds_read_b64_tr_b16 a[8:9], v6 offset:36864
  ds_read_b64_tr_b16 a[10:11], v6 offset:37888
  ds_read_b64_tr_b16 a[12:13], v8 offset:36864
  ds_read_b64_tr_b16 a[14:15], v8 offset:37888
  s_waitcnt lgkmcnt(8)
  v_mfma_f32_32x32x16_bf16 v[48:63], a[20:23], v[160:163], v[48:63]
  s_waitcnt vmcnt(9) lgkmcnt(6)
  v_mfma_f32_32x32x16_bf16 v[32:47], a[0:3], v[164:167], v[32:47]
  buffer_load_dwordx4 v[132:135], v13, s[24:27], s100 offen offset:1024 sc1
  ds_read_b64_tr_b16 a[16:17], v6 offset:38912
  ds_read_b64_tr_b16 a[18:19], v6 offset:39936
  ds_read_b64_tr_b16 a[20:21], v8 offset:38912
  ds_read_b64_tr_b16 a[22:23], v8 offset:39936
  s_waitcnt lgkmcnt(8)
  v_mfma_f32_32x32x16_bf16 v[48:63], a[4:7], v[164:167], v[48:63]
  s_add_u32 m0, s63, 28672
  s_lshl4_add_u32 s98, s76, s61
  buffer_load_dwordx4 v12, s[32:35], s98 offen lds
  s_waitcnt vmcnt(10) lgkmcnt(6)
  v_mfma_f32_32x32x16_bf16 v[32:47], a[8:11], v[168:171], v[32:47]
  buffer_load_dwordx4 v[136:139], v13, s[24:27], s100 offen offset:2048 sc1
  s_barrier
  s_lshl_b32 s49, s45, 7
  s_lshl_b32 s50, s46, 2
  s_add_u32 s49, s49, s50
  s_add_u32 s49, s49, 12288
  s_cmp_eq_u32 s44, 0
  s_cselect_b32 s49, s49, 1073741824
  v_mov_b32 v24, s47
  v_cmp_eq_u32 vcc, 0, v1
  v_mov_b32 v25, 1073741824
  s_nop 0
  v_cndmask_b32 v25, v25, 0, vcc
  buffer_store_dword v24, v25, s[24:27], s49 offen sc1
  ds_read_b64_tr_b16 a[0:1], v7 offset:8192
  ds_read_b64_tr_b16 a[2:3], v7 offset:9216
  ds_read_b64_tr_b16 a[4:5], v9 offset:8192
  ds_read_b64_tr_b16 a[6:7], v9 offset:9216
  s_waitcnt lgkmcnt(8)
  v_mfma_f32_32x32x16_bf16 v[48:63], a[12:15], v[168:171], v[48:63]
  s_waitcnt vmcnt(11) lgkmcnt(6)
  v_mfma_f32_32x32x16_bf16 v[32:47], a[16:19], v[172:175], v[32:47]
  s_cmp_eq_u32 s70, 40960
  s_cselect_b32 s68, 1073741824, s100
  buffer_load_dwordx4 v[140:143], v13, s[24:27], s68 offen offset:3072 sc1
  ds_read_b64_tr_b16 a[8:9], v7 offset:10240
  ds_read_b64_tr_b16 a[10:11], v7 offset:11264
  ds_read_b64_tr_b16 a[12:13], v9 offset:10240
  ds_read_b64_tr_b16 a[14:15], v9 offset:11264
  s_waitcnt lgkmcnt(8)
  v_mfma_f32_32x32x16_bf16 v[48:63], a[20:23], v[172:175], v[48:63]
  s_add_u32 m0, s63, 30720
  s_lshl4_add_u32 s98, s76, s61
  buffer_load_dwordx4 v227, s[32:35], s98 offen lds
  s_waitcnt vmcnt(12) lgkmcnt(6)
  v_mfma_f32_32x32x16_bf16 v[32:47], a[0:3], v[176:179], v[32:47]
  s_add_u32 s100, s59, s71
  buffer_load_dwordx4 v[144:147], v13, s[24:27], s100 offen offset:0 sc1
  ds_read_b64_tr_b16 a[16:17], v7 offset:12288
  ds_read_b64_tr_b16 a[18:19], v7 offset:13312
  ds_read_b64_tr_b16 a[20:21], v9 offset:12288
  ds_read_b64_tr_b16 a[22:23], v9 offset:13312
  s_waitcnt lgkmcnt(8)
  v_mfma_f32_32x32x16_bf16 v[48:63], a[4:7], v[176:179], v[48:63]
  s_waitcnt vmcnt(12) lgkmcnt(6)
  v_mfma_f32_32x32x16_bf16 v[32:47], a[8:11], v[180:183], v[32:47]
  buffer_load_dwordx4 v[148:151], v13, s[24:27], s100 offen offset:1024 sc1
  ds_read_b64_tr_b16 a[0:1], v7 offset:14336
  ds_read_b64_tr_b16 a[2:3], v7 offset:15360
  ds_read_b64_tr_b16 a[4:5], v9 offset:14336
  ds_read_b64_tr_b16 a[6:7], v9 offset:15360
  s_waitcnt lgkmcnt(8)
  v_mfma_f32_32x32x16_bf16 v[48:63], a[12:15], v[180:183], v[48:63]
  s_add_u32 m0, s63, 65536
  s_lshl4_add_u32 s98, s76, s61
  buffer_load_dwordx4 v228, s[32:35], s98 offen lds
  s_waitcnt vmcnt(13) lgkmcnt(6)
  v_mfma_f32_32x32x16_bf16 v[32:47], a[16:19], v[184:187], v[32:47]
  buffer_load_dwordx4 v[152:155], v13, s[24:27], s100 offen offset:2048 sc1
  s_barrier
  ds_read_b64_tr_b16 a[8:9], v6 offset:8192
  ds_read_b64_tr_b16 a[10:11], v6 offset:9216
  ds_read_b64_tr_b16 a[12:13], v8 offset:8192
  ds_read_b64_tr_b16 a[14:15], v8 offset:9216
  s_waitcnt lgkmcnt(8)
  v_mfma_f32_32x32x16_bf16 v[48:63], a[20:23], v[184:187], v[48:63]
  s_waitcnt vmcnt(12) lgkmcnt(6)
  v_mfma_f32_32x32x16_bf16 v[32:47], a[0:3], v[188:191], v[32:47]
  s_cmp_eq_u32 s71, 40960
  s_cselect_b32 s68, 1073741824, s100
  buffer_load_dwordx4 v[156:159], v13, s[24:27], s68 offen offset:3072 sc1
  ds_read_b64_tr_b16 a[16:17], v6 offset:10240
  ds_read_b64_tr_b16 a[18:19], v6 offset:11264
  ds_read_b64_tr_b16 a[20:21], v8 offset:10240
  ds_read_b64_tr_b16 a[22:23], v8 offset:11264
  s_waitcnt lgkmcnt(8)
  v_mfma_f32_32x32x16_bf16 v[48:63], a[4:7], v[188:191], v[48:63]
  s_add_u32 m0, s63, 67584
  s_lshl4_add_u32 s98, s76, s61
  buffer_load_dwordx4 v229, s[32:35], s98 offen lds
  s_waitcnt vmcnt(12) lgkmcnt(6)
  v_mfma_f32_32x32x16_bf16 v[32:47], a[8:11], v[128:131], v[32:47]
  s_add_u32 s100, s59, s72
  buffer_load_dwordx4 v[160:163], v13, s[24:27], s100 offen offset:0 sc1
  ds_read_b64_tr_b16 a[0:1], v6 offset:12288
  ds_read_b64_tr_b16 a[2:3], v6 offset:13312
  ds_read_b64_tr_b16 a[4:5], v8 offset:12288
  ds_read_b64_tr_b16 a[6:7], v8 offset:13312
  s_waitcnt lgkmcnt(8)
  v_mfma_f32_32x32x16_bf16 v[48:63], a[12:15], v[128:131], v[48:63]
  s_waitcnt vmcnt(12) lgkmcnt(6)
  v_mfma_f32_32x32x16_bf16 v[32:47], a[16:19], v[132:135], v[32:47]
  buffer_load_dwordx4 v[164:167], v13, s[24:27], s100 offen offset:1024 sc1
  ds_read_b64_tr_b16 a[8:9], v6 offset:14336
  ds_read_b64_tr_b16 a[10:11], v6 offset:15360
  ds_read_b64_tr_b16 a[12:13], v8 offset:14336
  ds_read_b64_tr_b16 a[14:15], v8 offset:15360
  s_waitcnt lgkmcnt(8)
  v_mfma_f32_32x32x16_bf16 v[48:63], a[20:23], v[132:135], v[48:63]
  s_add_u32 m0, s63, 69632
  s_lshl4_add_u32 s98, s77, s62
  buffer_load_dwordx4 v12, s[36:39], s98 offen lds
  s_waitcnt vmcnt(12) lgkmcnt(6)
  v_mfma_f32_32x32x16_bf16 v[32:47], a[0:3], v[136:139], v[32:47]
  buffer_load_dwordx4 v[168:171], v13, s[24:27], s100 offen offset:2048 sc1
  s_barrier
  ds_read_b64_tr_b16 a[16:17], v6 offset:16384
  ds_read_b64_tr_b16 a[18:19], v6 offset:17408
  ds_read_b64_tr_b16 a[20:21], v8 offset:16384
  ds_read_b64_tr_b16 a[22:23], v8 offset:17408
  s_waitcnt lgkmcnt(8)
  v_mfma_f32_32x32x16_bf16 v[48:63], a[4:7], v[136:139], v[48:63]
  s_waitcnt vmcnt(11) lgkmcnt(6)
  v_mfma_f32_32x32x16_bf16 v[32:47], a[8:11], v[140:143], v[32:47]
  s_cmp_eq_u32 s72, 40960
  s_cselect_b32 s68, 1073741824, s100
  buffer_load_dwordx4 v[172:175], v13, s[24:27], s68 offen offset:3072 sc1
  ds_read_b64_tr_b16 a[0:1], v6 offset:18432
  ds_read_b64_tr_b16 a[2:3], v6 offset:19456
  ds_read_b64_tr_b16 a[4:5], v8 offset:18432
  ds_read_b64_tr_b16 a[6:7], v8 offset:19456
  s_waitcnt lgkmcnt(8)
  v_mfma_f32_32x32x16_bf16 v[48:63], a[12:15], v[140:143], v[48:63]
  s_add_u32 m0, s63, 71680
  s_lshl4_add_u32 s98, s77, s62
  buffer_load_dwordx4 v227, s[36:39], s98 offen lds
  s_waitcnt vmcnt(11) lgkmcnt(6)
  v_mfma_f32_32x32x16_bf16 v[32:47], a[16:19], v[144:147], v[32:47]
  s_add_u32 s100, s59, s73
  buffer_load_dwordx4 v[176:179], v13, s[24:27], s100 offen offset:0 sc1
  ds_read_b64_tr_b16 a[8:9], v6 offset:20480
  ds_read_b64_tr_b16 a[10:11], v6 offset:21504
  ds_read_b64_tr_b16 a[12:13], v8 offset:20480
  ds_read_b64_tr_b16 a[14:15], v8 offset:21504
  s_waitcnt lgkmcnt(8)
  v_mfma_f32_32x32x16_bf16 v[48:63], a[20:23], v[144:147], v[48:63]
  s_waitcnt vmcnt(11) lgkmcnt(6)
  v_mfma_f32_32x32x16_bf16 v[32:47], a[0:3], v[148:151], v[32:47]
  buffer_load_dwordx4 v[180:183], v13, s[24:27], s100 offen offset:1024 sc1
  ds_read_b64_tr_b16 a[16:17], v6 offset:22528
  ds_read_b64_tr_b16 a[18:19], v6 offset:23552
  ds_read_b64_tr_b16 a[20:21], v8 offset:22528
  ds_read_b64_tr_b16 a[22:23], v8 offset:23552
  s_waitcnt lgkmcnt(8)
  v_mfma_f32_32x32x16_bf16 v[48:63], a[4:7], v[148:151], v[48:63]
  s_add_u32 m0, s63, 32768
  s_lshl4_add_u32 s98, s77, s62
  buffer_load_dwordx4 v228, s[36:39], s98 offen lds
  s_waitcnt vmcnt(11) lgkmcnt(6)
  v_mfma_f32_32x32x16_bf16 v[32:47], a[8:11], v[152:155], v[32:47]
  buffer_load_dwordx4 v[184:187], v13, s[24:27], s100 offen offset:2048 sc1
  s_barrier
  ds_read_b64_tr_b16 a[0:1], v6 offset:49152
  ds_read_b64_tr_b16 a[2:3], v6 offset:50176
  ds_read_b64_tr_b16 a[4:5], v8 offset:49152
  ds_read_b64_tr_b16 a[6:7], v8 offset:50176
  s_waitcnt lgkmcnt(8)
  v_mfma_f32_32x32x16_bf16 v[48:63], a[12:15], v[152:155], v[48:63]
  s_waitcnt vmcnt(11) lgkmcnt(6)
  v_mfma_f32_32x32x16_bf16 v[32:47], a[16:19], v[156:159], v[32:47]
  s_cmp_eq_u32 s73, 40960
  s_cselect_b32 s68, 1073741824, s100
  buffer_load_dwordx4 v[188:191], v13, s[24:27], s68 offen offset:3072 sc1
  ds_read_b64_tr_b16 a[8:9], v6 offset:51200
  ds_read_b64_tr_b16 a[10:11], v6 offset:52224
  ds_read_b64_tr_b16 a[12:13], v8 offset:51200
  ds_read_b64_tr_b16 a[14:15], v8 offset:52224
  s_waitcnt lgkmcnt(8)
  v_mfma_f32_32x32x16_bf16 v[48:63], a[20:23], v[156:159], v[48:63]
  s_add_u32 m0, s63, 34816
  s_lshl4_add_u32 s98, s77, s62
  buffer_load_dwordx4 v229, s[36:39], s98 offen lds
  s_waitcnt vmcnt(11) lgkmcnt(6)
  v_mfma_f32_32x32x16_bf16 v[32:47], a[0:3], v[160:163], v[32:47]
  s_add_u32 s100, s59, s74
  buffer_load_dwordx4 v[128:131], v13, s[24:27], s100 offen offset:0 sc1
  ds_read_b64_tr_b16 a[16:17], v6 offset:53248
  ds_read_b64_tr_b16 a[18:19], v6 offset:54272
  ds_read_b64_tr_b16 a[20:21], v8 offset:53248
  ds_read_b64_tr_b16 a[22:23], v8 offset:54272
  s_waitcnt lgkmcnt(8)
  v_mfma_f32_32x32x16_bf16 v[48:63], a[4:7], v[160:163], v[48:63]
  s_waitcnt vmcnt(11) lgkmcnt(6)
  v_mfma_f32_32x32x16_bf16 v[32:47], a[8:11], v[164:167], v[32:47]
  buffer_load_dwordx4 v[132:135], v13, s[24:27], s100 offen offset:1024 sc1
  ds_read_b64_tr_b16 a[0:1], v6 offset:55296
  ds_read_b64_tr_b16 a[2:3], v6 offset:56320
  ds_read_b64_tr_b16 a[4:5], v8 offset:55296
  ds_read_b64_tr_b16 a[6:7], v8 offset:56320
  s_waitcnt lgkmcnt(8)
  v_mfma_f32_32x32x16_bf16 v[48:63], a[12:15], v[164:167], v[48:63]
  s_add_u32 m0, s63, 36864
  s_lshl4_add_u32 s98, s3, s62
  buffer_load_dwordx4 v12, s[36:39], s98 offen lds
  s_waitcnt vmcnt(11) lgkmcnt(6)
  v_mfma_f32_32x32x16_bf16 v[32:47], a[16:19], v[168:171], v[32:47]
  buffer_load_dwordx4 v[136:139], v13, s[24:27], s100 offen offset:2048 sc1
  s_barrier
  ds_read_b64_tr_b16 a[8:9], v6 offset:57344
  ds_read_b64_tr_b16 a[10:11], v6 offset:58368
  ds_read_b64_tr_b16 a[12:13], v8 offset:57344
  ds_read_b64_tr_b16 a[14:15], v8 offset:58368
  s_waitcnt lgkmcnt(8)
  v_mfma_f32_32x32x16_bf16 v[48:63], a[20:23], v[168:171], v[48:63]
  s_waitcnt vmcnt(11) lgkmcnt(6)
  v_mfma_f32_32x32x16_bf16 v[32:47], a[0:3], v[172:175], v[32:47]
  s_cmp_eq_u32 s74, 40960
  s_cselect_b32 s68, 1073741824, s100
  buffer_load_dwordx4 v[140:143], v13, s[24:27], s68 offen offset:3072 sc1
  ds_read_b64_tr_b16 a[16:17], v6 offset:59392
  ds_read_b64_tr_b16 a[18:19], v6 offset:60416
  ds_read_b64_tr_b16 a[20:21], v8 offset:59392
  ds_read_b64_tr_b16 a[22:23], v8 offset:60416
  s_waitcnt lgkmcnt(8)
  v_mfma_f32_32x32x16_bf16 v[48:63], a[4:7], v[172:175], v[48:63]
  s_add_u32 m0, s63, 38912
  s_lshl4_add_u32 s98, s3, s62
  buffer_load_dwordx4 v227, s[36:39], s98 offen lds
  s_waitcnt vmcnt(11) lgkmcnt(6)
  v_mfma_f32_32x32x16_bf16 v[32:47], a[8:11], v[176:179], v[32:47]
  s_add_u32 s100, s59, s75
  buffer_load_dwordx4 v[144:147], v13, s[24:27], s100 offen offset:0 sc1
  ds_read_b64_tr_b16 a[0:1], v6 offset:61440
  ds_read_b64_tr_b16 a[2:3], v6 offset:62464
  ds_read_b64_tr_b16 a[4:5], v8 offset:61440
  ds_read_b64_tr_b16 a[6:7], v8 offset:62464
  s_waitcnt lgkmcnt(8)
  v_mfma_f32_32x32x16_bf16 v[48:63], a[12:15], v[176:179], v[48:63]
  s_add_u32 m0, s63, 73728
  s_lshl4_add_u32 s98, s3, s62
  buffer_load_dwordx4 v228, s[36:39], s98 offen lds
  s_waitcnt vmcnt(12) lgkmcnt(6)
  v_mfma_f32_32x32x16_bf16 v[32:47], a[16:19], v[180:183], v[32:47]
  buffer_load_dwordx4 v[148:151], v13, s[24:27], s100 offen offset:1024 sc1
  ds_read_b64_tr_b16 a[8:9], v6 offset:63488
  ds_read_b64_tr_b16 a[10:11], v6 offset:64512
  ds_read_b64_tr_b16 a[12:13], v8 offset:63488
  ds_read_b64_tr_b16 a[14:15], v8 offset:64512
  s_waitcnt lgkmcnt(8)
  v_mfma_f32_32x32x16_bf16 v[48:63], a[20:23], v[180:183], v[48:63]
  s_waitcnt vmcnt(11) lgkmcnt(6)
  v_mfma_f32_32x32x16_bf16 v[32:47], a[0:3], v[184:187], v[32:47]
  buffer_load_dwordx4 v[152:155], v13, s[24:27], s100 offen offset:2048 sc1
  s_barrier
  ds_read_b64_tr_b16 a[16:17], v6 offset:0
  ds_read_b64_tr_b16 a[18:19], v6 offset:1024
  ds_read_b64_tr_b16 a[20:21], v8 offset:0
  ds_read_b64_tr_b16 a[22:23], v8 offset:1024
  s_waitcnt lgkmcnt(8)
  v_mfma_f32_32x32x16_bf16 v[48:63], a[4:7], v[184:187], v[48:63]
  s_add_u32 m0, s63, 75776
  s_lshl4_add_u32 s98, s3, s62
  buffer_load_dwordx4 v229, s[36:39], s98 offen lds
  s_waitcnt vmcnt(12) lgkmcnt(6)
  v_mfma_f32_32x32x16_bf16 v[32:47], a[8:11], v[188:191], v[32:47]
  s_cmp_eq_u32 s75, 40960
  s_cselect_b32 s68, 1073741824, s100
  buffer_load_dwordx4 v[156:159], v13, s[24:27], s68 offen offset:3072 sc1
  ds_read_b64_tr_b16 a[0:1], v6 offset:2048
  ds_read_b64_tr_b16 a[2:3], v6 offset:3072
  ds_read_b64_tr_b16 a[4:5], v8 offset:2048
  ds_read_b64_tr_b16 a[6:7], v8 offset:3072
  s_waitcnt lgkmcnt(8)
  v_mfma_f32_32x32x16_bf16 v[48:63], a[12:15], v[188:191], v[48:63]
  s_waitcnt vmcnt(11) lgkmcnt(6)
  v_mfma_f32_32x32x16_bf16 v[32:47], a[16:19], v[128:131], v[32:47]
  s_add_u32 s100, s59, s76
  buffer_load_dwordx4 v[160:163], v13, s[24:27], s100 offen offset:0 sc1
  ds_read_b64_tr_b16 a[8:9], v6 offset:4096
  ds_read_b64_tr_b16 a[10:11], v6 offset:5120
  ds_read_b64_tr_b16 a[12:13], v8 offset:4096
  ds_read_b64_tr_b16 a[14:15], v8 offset:5120
  s_waitcnt lgkmcnt(8)
  v_mfma_f32_32x32x16_bf16 v[48:63], a[20:23], v[128:131], v[48:63]
  s_add_u32 m0, s63, 77824
  s_lshl4_add_u32 s98, s4, s62
  buffer_load_dwordx4 v12, s[36:39], s98 offen lds
  s_waitcnt vmcnt(12) lgkmcnt(6)
  v_mfma_f32_32x32x16_bf16 v[32:47], a[0:3], v[132:135], v[32:47]
  s_lshl_b32 s49, s69, 7
  s_add_u32 s49, s49, 12288
  v_and_b32 v24, 15, v1
  v_lshlrev_b32 v24, 2, v24
  buffer_load_dword v31, v24, s[24:27], s49 offen sc1
  buffer_load_dwordx4 v[164:167], v13, s[24:27], s100 offen offset:1024 sc1
  ds_read_b64_tr_b16 a[16:17], v6 offset:40960
  ds_read_b64_tr_b16 a[18:19], v6 offset:41984
  ds_read_b64_tr_b16 a[20:21], v8 offset:40960
  ds_read_b64_tr_b16 a[22:23], v8 offset:41984
  s_waitcnt lgkmcnt(8)
  v_mfma_f32_32x32x16_bf16 v[48:63], a[4:7], v[132:135], v[48:63]
  s_waitcnt vmcnt(12) lgkmcnt(6)
  v_mfma_f32_32x32x16_bf16 v[32:47], a[8:11], v[136:139], v[32:47]
  buffer_load_dwordx4 v[168:171], v13, s[24:27], s100 offen offset:2048 sc1
  s_barrier
  ds_read_b64_tr_b16 a[0:1], v6 offset:43008
  ds_read_b64_tr_b16 a[2:3], v6 offset:44032
  ds_read_b64_tr_b16 a[4:5], v8 offset:43008
  ds_read_b64_tr_b16 a[6:7], v8 offset:44032
  s_waitcnt lgkmcnt(8)
  v_mfma_f32_32x32x16_bf16 v[48:63], a[12:15], v[136:139], v[48:63]
  s_add_u32 m0, s63, 79872
  s_lshl4_add_u32 s98, s4, s62
  buffer_load_dwordx4 v227, s[36:39], s98 offen lds
  s_waitcnt vmcnt(13) lgkmcnt(6)
  v_mfma_f32_32x32x16_bf16 v[32:47], a[16:19], v[140:143], v[32:47]
  s_cmp_eq_u32 s76, 40960
  s_cselect_b32 s68, 1073741824, s100
  buffer_load_dwordx4 v[172:175], v13, s[24:27], s68 offen offset:3072 sc1
  ds_read_b64_tr_b16 a[8:9], v6 offset:45056
  ds_read_b64_tr_b16 a[10:11], v6 offset:46080
  ds_read_b64_tr_b16 a[12:13], v8 offset:45056
  ds_read_b64_tr_b16 a[14:15], v8 offset:46080
  s_waitcnt lgkmcnt(8)
  v_mfma_f32_32x32x16_bf16 v[48:63], a[20:23], v[140:143], v[48:63]
  s_waitcnt vmcnt(12) lgkmcnt(6)
  v_mfma_f32_32x32x16_bf16 v[32:47], a[0:3], v[144:147], v[32:47]
  s_waitcnt vmcnt(4)
  v_cmp_ne_u32 vcc, s47, v31
  s_lshl_b32 s49, s69, 7
  s_add_u32 s49, s49, 12288
  v_and_b32 v24, 15, v1
  v_lshlrev_b32 v24, 2, v24
  s_mov_b32 s68, 1000000
  s_cbranch_vccz L_poll3_done
L_poll3:
  buffer_load_dword v31, v24, s[24:27], s49 offen sc1
  s_waitcnt vmcnt(0)
  v_cmp_ne_u32 vcc, s47, v31
  s_nop 4
  s_cbranch_vccz L_poll3_done
  s_sub_u32 s68, s68, 1
  s_cmp_eq_u32 s68, 0
  s_cbranch_scc1 L_poll3_done
  s_sleep 1
  s_branch L_poll3
L_poll3_done:
  s_add_u32 s100, s60, s77
  buffer_load_dwordx4 v[176:179], v13, s[24:27], s100 offen offset:0 sc1
  ds_read_b64_tr_b16 a[16:17], v6 offset:24576
  ds_read_b64_tr_b16 a[18:19], v6 offset:25600
  ds_read_b64_tr_b16 a[20:21], v8 offset:24576
  ds_read_b64_tr_b16 a[22:23], v8 offset:25600
  s_waitcnt lgkmcnt(8)
  v_mfma_f32_32x32x16_bf16 v[48:63], a[4:7], v[144:147], v[48:63]
  s_add_u32 m0, s63, 8192
  s_lshl4_add_u32 s98, s4, s62
  buffer_load_dwordx4 v228, s[36:39], s98 offen lds
  s_waitcnt lgkmcnt(6)
  v_mfma_f32_32x32x16_bf16 v[32:47], a[8:11], v[148:151], v[32:47]
  buffer_load_dwordx4 v[180:183], v13, s[24:27], s100 offen offset:1024 sc1
  ds_read_b64_tr_b16 a[0:1], v6 offset:26624
  ds_read_b64_tr_b16 a[2:3], v6 offset:27648
  ds_read_b64_tr_b16 a[4:5], v8 offset:26624
  ds_read_b64_tr_b16 a[6:7], v8 offset:27648
  s_waitcnt lgkmcnt(8)
  v_mfma_f32_32x32x16_bf16 v[48:63], a[12:15], v[148:151], v[48:63]
  s_waitcnt lgkmcnt(6)
  v_mfma_f32_32x32x16_bf16 v[32:47], a[16:19], v[152:155], v[32:47]
  buffer_load_dwordx4 v[184:187], v13, s[24:27], s100 offen offset:2048 sc1
  s_barrier
  ds_read_b64_tr_b16 a[8:9], v6 offset:28672
  ds_read_b64_tr_b16 a[10:11], v6 offset:29696
  ds_read_b64_tr_b16 a[12:13], v8 offset:28672
  ds_read_b64_tr_b16 a[14:15], v8 offset:29696
  s_waitcnt lgkmcnt(8)
  v_mfma_f32_32x32x16_bf16 v[48:63], a[20:23], v[152:155], v[48:63]
  s_add_u32 m0, s63, 10240
  s_lshl4_add_u32 s98, s4, s62
  buffer_load_dwordx4 v229, s[36:39], s98 offen lds
  s_waitcnt lgkmcnt(6)
  v_mfma_f32_32x32x16_bf16 v[32:47], a[0:3], v[156:159], v[32:47]
  buffer_load_dwordx4 v[188:191], v13, s[24:27], s100 offen offset:3072 sc1
  ds_read_b64_tr_b16 a[16:17], v6 offset:30720
  ds_read_b64_tr_b16 a[18:19], v6 offset:31744
  ds_read_b64_tr_b16 a[20:21], v8 offset:30720
  ds_read_b64_tr_b16 a[22:23], v8 offset:31744
  s_waitcnt lgkmcnt(8)
  v_mfma_f32_32x32x16_bf16 v[48:63], a[4:7], v[156:159], v[48:63]
  s_waitcnt lgkmcnt(6)
  v_mfma_f32_32x32x16_bf16 v[32:47], a[8:11], v[160:163], v[32:47]
  s_add_u32 s100, s60, s3
  buffer_load_dwordx4 v[128:131], v13, s[24:27], s100 offen offset:0 sc1
  ds_read_b64_tr_b16 a[0:1], v7 offset:0
  ds_read_b64_tr_b16 a[2:3], v7 offset:1024
  ds_read_b64_tr_b16 a[4:5], v9 offset:0
  ds_read_b64_tr_b16 a[6:7], v9 offset:1024
  s_waitcnt lgkmcnt(8)
  v_mfma_f32_32x32x16_bf16 v[48:63], a[12:15], v[160:163], v[48:63]
  s_add_u32 m0, s63, 12288
  s_lshl4_add_u32 s98, s5, s62
  buffer_load_dwordx4 v12, s[36:39], s98 offen lds
  s_waitcnt vmcnt(11) lgkmcnt(6)
  v_mfma_f32_32x32x16_bf16 v[32:47], a[16:19], v[164:167], v[32:47]
  buffer_load_dwordx4 v[132:135], v13, s[24:27], s100 offen offset:1024 sc1
  ds_read_b64_tr_b16 a[8:9], v7 offset:2048
  ds_read_b64_tr_b16 a[10:11], v7 offset:3072
  ds_read_b64_tr_b16 a[12:13], v9 offset:2048
  ds_read_b64_tr_b16 a[14:15], v9 offset:3072
  s_waitcnt lgkmcnt(8)
  v_mfma_f32_32x32x16_bf16 v[48:63], a[20:23], v[164:167], v[48:63]
  s_waitcnt vmcnt(11) lgkmcnt(6)
  v_mfma_f32_32x32x16_bf16 v[32:47], a[0:3], v[168:171], v[32:47]
  buffer_load_dwordx4 v[136:139], v13, s[24:27], s100 offen offset:2048 sc1
  s_barrier
  ds_read_b64_tr_b16 a[16:17], v7 offset:4096
  ds_read_b64_tr_b16 a[18:19], v7 offset:5120
  ds_read_b64_tr_b16 a[20:21], v9 offset:4096
  ds_read_b64_tr_b16 a[22:23], v9 offset:5120
  s_waitcnt lgkmcnt(8)
  v_mfma_f32_32x32x16_bf16 v[48:63], a[4:7], v[168:171], v[48:63]
  s_add_u32 m0, s63, 14336
  s_lshl4_add_u32 s98, s5, s62
  buffer_load_dwordx4 v227, s[36:39], s98 offen lds
  s_waitcnt vmcnt(11) lgkmcnt(6)
  v_mfma_f32_32x32x16_bf16 v[32:47], a[8:11], v[172:175], v[32:47]
  buffer_load_dwordx4 v[140:143], v13, s[24:27], s100 offen offset:3072 sc1
  ds_read_b64_tr_b16 a[0:1], v7 offset:6144
  ds_read_b64_tr_b16 a[2:3], v7 offset:7168
  ds_read_b64_tr_b16 a[4:5], v9 offset:6144
  ds_read_b64_tr_b16 a[6:7], v9 offset:7168
  s_waitcnt lgkmcnt(8)
  v_mfma_f32_32x32x16_bf16 v[48:63], a[12:15], v[172:175], v[48:63]
  s_waitcnt vmcnt(11) lgkmcnt(6)
  v_mfma_f32_32x32x16_bf16 v[64:79], a[16:19], v[176:179], 0
  s_add_u32 s100, s60, s4
  buffer_load_dwordx4 v[144:147], v13, s[24:27], s100 offen offset:0 sc1
  ds_read_b64_tr_b16 a[8:9], v6 offset:32768
  ds_read_b64_tr_b16 a[10:11], v6 offset:33792
  ds_read_b64_tr_b16 a[12:13], v8 offset:32768
  ds_read_b64_tr_b16 a[14:15], v8 offset:33792
  s_waitcnt lgkmcnt(8)
  v_mfma_f32_32x32x16_bf16 v[80:95], a[20:23], v[176:179], 0
  s_add_u32 m0, s63, 16384
  s_lshl4_add_u32 s98, s5, s62
  buffer_load_dwordx4 v228, s[36:39], s98 offen lds
  s_add_u32 m0, s63, 18432
  s_lshl4_add_u32 s98, s5, s62
  buffer_load_dwordx4 v229, s[36:39], s98 offen lds
  s_waitcnt vmcnt(12) lgkmcnt(6)
  v_mfma_f32_32x32x16_bf16 v[64:79], a[0:3], v[180:183], v[64:79]
  buffer_load_dwordx4 v[148:151], v13, s[24:27], s100 offen offset:1024 sc1
  ds_read_b64_tr_b16 a[16:17], v6 offset:34816
  ds_read_b64_tr_b16 a[18:19], v6 offset:35840
  ds_read_b64_tr_b16 a[20:21], v8 offset:34816
  ds_read_b64_tr_b16 a[22:23], v8 offset:35840
  s_waitcnt lgkmcnt(8)
  v_mfma_f32_32x32x16_bf16 v[80:95], a[4:7], v[180:183], v[80:95]
  s_waitcnt vmcnt(12) lgkmcnt(6)
  v_mfma_f32_32x32x16_bf16 v[64:79], a[8:11], v[184:187], v[64:79]
  buffer_load_dwordx4 v[152:155], v13, s[24:27], s100 offen offset:2048 sc1
  s_barrier
  ds_read_b64_tr_b16 a[0:1], v6 offset:36864
  ds_read_b64_tr_b16 a[2:3], v6 offset:37888
  ds_read_b64_tr_b16 a[4:5], v8 offset:36864
  ds_read_b64_tr_b16 a[6:7], v8 offset:37888
  s_waitcnt lgkmcnt(8)
  v_mfma_f32_32x32x16_bf16 v[80:95], a[12:15], v[184:187], v[80:95]
  s_waitcnt vmcnt(11) lgkmcnt(6)
  v_mfma_f32_32x32x16_bf16 v[64:79], a[16:19], v[188:191], v[64:79]
  buffer_load_dwordx4 v[156:159], v13, s[24:27], s100 offen offset:3072 sc1
  ds_read_b64_tr_b16 a[8:9], v6 offset:38912
  ds_read_b64_tr_b16 a[10:11], v6 offset:39936
  ds_read_b64_tr_b16 a[12:13], v8 offset:38912
  ds_read_b64_tr_b16 a[14:15], v8 offset:39936
  s_waitcnt lgkmcnt(8)
  v_mfma_f32_32x32x16_bf16 v[80:95], a[20:23], v[188:191], v[80:95]
  s_waitcnt vmcnt(11) lgkmcnt(6)
  v_mfma_f32_32x32x16_bf16 v[64:79], a[0:3], v[128:131], v[64:79]
  s_add_u32 s100, s60, s5
  buffer_load_dwordx4 v[160:163], v13, s[24:27], s100 offen offset:0 sc1
  ds_read_b64_tr_b16 a[16:17], v7 offset:8192
  ds_read_b64_tr_b16 a[18:19], v7 offset:9216
  ds_read_b64_tr_b16 a[20:21], v9 offset:8192
  ds_read_b64_tr_b16 a[22:23], v9 offset:9216
  s_waitcnt lgkmcnt(8)
  v_mfma_f32_32x32x16_bf16 v[80:95], a[4:7], v[128:131], v[80:95]
  s_waitcnt vmcnt(10) lgkmcnt(6)
  v_mfma_f32_32x32x16_bf16 v[64:79], a[8:11], v[132:135], v[64:79]
  buffer_load_dwordx4 v[164:167], v13, s[24:27], s100 offen offset:1024 sc1
  ds_read_b64_tr_b16 a[0:1], v7 offset:10240
  ds_read_b64_tr_b16 a[2:3], v7 offset:11264
  ds_read_b64_tr_b16 a[4:5], v9 offset:10240
  ds_read_b64_tr_b16 a[6:7], v9 offset:11264
  s_waitcnt lgkmcnt(8)
  v_mfma_f32_32x32x16_bf16 v[80:95], a[12:15], v[132:135], v[80:95]
  s_waitcnt vmcnt(10) lgkmcnt(6)
  v_mfma_f32_32x32x16_bf16 v[64:79], a[16:19], v[136:139], v[64:79]
  buffer_load_dwordx4 v[168:171], v13, s[24:27], s100 offen offset:2048 sc1
  s_barrier
  ds_read_b64_tr_b16 a[8:9], v7 offset:12288
  ds_read_b64_tr_b16 a[10:11], v7 offset:13312
  ds_read_b64_tr_b16 a[12:13], v9 offset:12288
  ds_read_b64_tr_b16 a[14:15], v9 offset:13312
  s_waitcnt lgkmcnt(8)
  v_mfma_f32_32x32x16_bf16 v[80:95], a[20:23], v[136:139], v[80:95]
  s_waitcnt vmcnt(9) lgkmcnt(6)
  v_mfma_f32_32x32x16_bf16 v[64:79], a[0:3], v[140:143], v[64:79]
  buffer_load_dwordx4 v[172:175], v13, s[24:27], s100 offen offset:3072 sc1
  ds_read_b64_tr_b16 a[16:17], v7 offset:14336
  ds_read_b64_tr_b16 a[18:19], v7 offset:15360
  ds_read_b64_tr_b16 a[20:21], v9 offset:14336
  ds_read_b64_tr_b16 a[22:23], v9 offset:15360
  s_waitcnt lgkmcnt(8)
  v_mfma_f32_32x32x16_bf16 v[80:95], a[4:7], v[140:143], v[80:95]
  s_waitcnt vmcnt(9) lgkmcnt(6)
  v_mfma_f32_32x32x16_bf16 v[64:79], a[8:11], v[144:147], v[64:79]
  ds_read_b64_tr_b16 a[0:1], v6 offset:8192
  ds_read_b64_tr_b16 a[2:3], v6 offset:9216
  ds_read_b64_tr_b16 a[4:5], v8 offset:8192
  ds_read_b64_tr_b16 a[6:7], v8 offset:9216
  s_waitcnt lgkmcnt(8)
  v_mfma_f32_32x32x16_bf16 v[80:95], a[12:15], v[144:147], v[80:95]
  s_waitcnt vmcnt(6) lgkmcnt(6)
  v_mfma_f32_32x32x16_bf16 v[64:79], a[16:19], v[148:151], v[64:79]
  ds_read_b64_tr_b16 a[8:9], v6 offset:10240
  ds_read_b64_tr_b16 a[10:11], v6 offset:11264
  ds_read_b64_tr_b16 a[12:13], v8 offset:10240
  ds_read_b64_tr_b16 a[14:15], v8 offset:11264
  s_waitcnt lgkmcnt(8)
  v_mfma_f32_32x32x16_bf16 v[80:95], a[20:23], v[148:151], v[80:95]
  s_waitcnt vmcnt(5) lgkmcnt(6)
  v_mfma_f32_32x32x16_bf16 v[64:79], a[0:3], v[152:155], v[64:79]
  s_barrier
  ds_read_b64_tr_b16 a[16:17], v6 offset:12288
  ds_read_b64_tr_b16 a[18:19], v6 offset:13312
  ds_read_b64_tr_b16 a[20:21], v8 offset:12288
  ds_read_b64_tr_b16 a[22:23], v8 offset:13312
  s_waitcnt lgkmcnt(8)
  v_mfma_f32_32x32x16_bf16 v[80:95], a[4:7], v[152:155], v[80:95]
  s_waitcnt vmcnt(4) lgkmcnt(6)
  v_mfma_f32_32x32x16_bf16 v[64:79], a[8:11], v[156:159], v[64:79]
  ds_read_b64_tr_b16 a[0:1], v6 offset:14336
  ds_read_b64_tr_b16 a[2:3], v6 offset:15360
  ds_read_b64_tr_b16 a[4:5], v8 offset:14336
  ds_read_b64_tr_b16 a[6:7], v8 offset:15360
  s_waitcnt lgkmcnt(8)
  v_mfma_f32_32x32x16_bf16 v[80:95], a[12:15], v[156:159], v[80:95]
  s_waitcnt vmcnt(3) lgkmcnt(6)
  v_mfma_f32_32x32x16_bf16 v[64:79], a[16:19], v[160:163], v[64:79]
  ds_read_b64_tr_b16 a[8:9], v6 offset:16384
  ds_read_b64_tr_b16 a[10:11], v6 offset:17408
  ds_read_b64_tr_b16 a[12:13], v8 offset:16384
  ds_read_b64_tr_b16 a[14:15], v8 offset:17408
  s_waitcnt lgkmcnt(8)
  v_mfma_f32_32x32x16_bf16 v[80:95], a[20:23], v[160:163], v[80:95]
  s_waitcnt vmcnt(2) lgkmcnt(6)
  v_mfma_f32_32x32x16_bf16 v[64:79], a[0:3], v[164:167], v[64:79]
  ds_read_b64_tr_b16 a[16:17], v6 offset:18432
  ds_read_b64_tr_b16 a[18:19], v6 offset:19456
  ds_read_b64_tr_b16 a[20:21], v8 offset:18432
  ds_read_b64_tr_b16 a[22:23], v8 offset:19456
  s_waitcnt lgkmcnt(8)
  v_mfma_f32_32x32x16_bf16 v[80:95], a[4:7], v[164:167], v[80:95]
  s_waitcnt vmcnt(1) lgkmcnt(6)
  v_mfma_f32_32x32x16_bf16 v[64:79], a[8:11], v[168:171], v[64:79]
  s_waitcnt lgkmcnt(4)
  v_mfma_f32_32x32x16_bf16 v[80:95], a[12:15], v[168:171], v[80:95]
  s_waitcnt vmcnt(0) lgkmcnt(2)
  v_mfma_f32_32x32x16_bf16 v[64:79], a[16:19], v[172:175], v[64:79]
  s_waitcnt lgkmcnt(0)
  v_mfma_f32_32x32x16_bf16 v[80:95], a[20:23], v[172:175], v[80:95]
  v_add_u32 v17, s48, v13
  s_xor_b32 s49, s44, 2
  s_mul_i32 s49, s49, 40960
  v_add_u32 v18, s49, v13
  ds_write_b128 v17, v[48:51] offset:0
  ds_write_b128 v17, v[52:55] offset:1024
  ds_write_b128 v17, v[56:59] offset:2048
  ds_write_b128 v17, v[60:63] offset:3072
  s_nop 3
  ds_write_b128 v17, v[80:83] offset:4096
  ds_write_b128 v17, v[84:87] offset:5120
  ds_write_b128 v17, v[88:91] offset:6144
  ds_write_b128 v17, v[92:95] offset:7168
  v_lshlrev_b32 v144, 16, v232
  v_and_b32 v145, 0xffff0000, v232
  v_lshlrev_b32 v146, 16, v233
  v_and_b32 v147, 0xffff0000, v233
  v_lshlrev_b32 v148, 16, v234
  v_and_b32 v149, 0xffff0000, v234
  v_lshlrev_b32 v150, 16, v235
  v_and_b32 v151, 0xffff0000, v235
  v_lshlrev_b32 v152, 16, v236
  v_and_b32 v153, 0xffff0000, v236
  v_lshlrev_b32 v154, 16, v237
  v_and_b32 v155, 0xffff0000, v237
  v_lshlrev_b32 v156, 16, v238
  v_and_b32 v157, 0xffff0000, v238
  v_lshlrev_b32 v158, 16, v239
  v_and_b32 v159, 0xffff0000, v239
  s_waitcnt lgkmcnt(0)
  s_barrier
  ds_read_b128 v[96:99], v18 offset:0
  ds_read_b128 v[100:103], v18 offset:1024
  ds_read_b128 v[104:107], v18 offset:2048
  ds_read_b128 v[108:111], v18 offset:3072
  ds_read_b128 v[112:115], v18 offset:4096
  ds_read_b128 v[116:119], v18 offset:5120
  ds_read_b128 v[120:123], v18 offset:6144
  ds_read_b128 v[124:127], v18 offset:7168
  s_or_b32 s49, s2, s44
  s_cmp_eq_u32 s49, 0
  s_cselect_b32 s49, 0, 1073741824
  v_mov_b32 v24, s47
  v_cmp_eq_u32 vcc, 0, v1
  v_mov_b32 v25, 1073741824
  s_nop 0
  v_cndmask_b32 v25, v25, 0, vcc
  buffer_store_dword v24, v25, s[24:27], s49 offen sc1
  s_mov_b32 s6, 0xbfb8aa3b
  s_mov_b32 s7, 0xbfb8aa3b
  s_waitcnt lgkmcnt(7)
  v_pk_add_f32 v[32:33], v[32:33], v[96:97]
  v_pk_add_f32 v[34:35], v[34:35], v[98:99]
  s_waitcnt lgkmcnt(6)
  v_pk_add_f32 v[36:37], v[36:37], v[100:101]
  v_pk_add_f32 v[38:39], v[38:39], v[102:103]
  s_waitcnt lgkmcnt(5)
  v_pk_add_f32 v[40:41], v[40:41], v[104:105]
  v_pk_add_f32 v[42:43], v[42:43], v[106:107]
  s_waitcnt lgkmcnt(4)
  v_pk_add_f32 v[44:45], v[44:45], v[108:109]
  v_pk_add_f32 v[46:47], v[46:47], v[110:111]
  v_pk_mul_f32 v[128:129], v[32:33], s[6:7]
  v_pk_mul_f32 v[130:131], v[34:35], s[6:7]
  v_pk_mul_f32 v[132:133], v[36:37], s[6:7]
  v_pk_mul_f32 v[134:135], v[38:39], s[6:7]
  v_pk_mul_f32 v[136:137], v[40:41], s[6:7]
  v_pk_mul_f32 v[138:139], v[42:43], s[6:7]
  v_pk_mul_f32 v[140:141], v[44:45], s[6:7]
  v_pk_mul_f32 v[142:143], v[46:47], s[6:7]
  v_exp_f32 v128, v128
  v_exp_f32 v129, v129
  v_exp_f32 v130, v130
  v_exp_f32 v131, v131
  v_exp_f32 v132, v132
  v_exp_f32 v133, v133
  v_exp_f32 v134, v134
  v_exp_f32 v135, v135
  v_exp_f32 v136, v136
  v_exp_f32 v137, v137
  v_exp_f32 v138, v138
  v_exp_f32 v139, v139
  v_exp_f32 v140, v140
  v_exp_f32 v141, v141
  v_exp_f32 v142, v142
  v_exp_f32 v143, v143
  s_waitcnt lgkmcnt(3)
  v_pk_add_f32 v[64:65], v[64:65], v[112:113]
  v_pk_add_f32 v[66:67], v[66:67], v[114:115]
  s_waitcnt lgkmcnt(2)
  v_pk_add_f32 v[68:69], v[68:69], v[116:117]
  v_pk_add_f32 v[70:71], v[70:71], v[118:119]
  s_waitcnt lgkmcnt(1)
  v_pk_add_f32 v[72:73], v[72:73], v[120:121]
  v_pk_add_f32 v[74:75], v[74:75], v[122:123]
  s_waitcnt lgkmcnt(0)
  v_pk_add_f32 v[76:77], v[76:77], v[124:125]
  v_pk_add_f32 v[78:79], v[78:79], v[126:127]
  v_pk_add_f32 v[128:129], v[128:129], 1.0 op_sel_hi:[1,0]
  v_pk_add_f32 v[130:131], v[130:131], 1.0 op_sel_hi:[1,0]
  v_pk_add_f32 v[132:133], v[132:133], 1.0 op_sel_hi:[1,0]
  v_pk_add_f32 v[134:135], v[134:135], 1.0 op_sel_hi:[1,0]
  v_pk_add_f32 v[136:137], v[136:137], 1.0 op_sel_hi:[1,0]
  v_pk_add_f32 v[138:139], v[138:139], 1.0 op_sel_hi:[1,0]
  v_pk_add_f32 v[140:141], v[140:141], 1.0 op_sel_hi:[1,0]
  v_pk_add_f32 v[142:143], v[142:143], 1.0 op_sel_hi:[1,0]
  v_rcp_f32 v128, v128
  v_rcp_f32 v129, v129
  v_rcp_f32 v130, v130
  v_rcp_f32 v131, v131
  v_rcp_f32 v132, v132
  v_rcp_f32 v133, v133
  v_rcp_f32 v134, v134
  v_rcp_f32 v135, v135
  v_rcp_f32 v136, v136
  v_rcp_f32 v137, v137
  v_rcp_f32 v138, v138
  v_rcp_f32 v139, v139
  v_rcp_f32 v140, v140
  v_rcp_f32 v141, v141
  v_rcp_f32 v142, v142
  v_rcp_f32 v143, v143
  v_pk_mul_f32 v[32:33], v[32:33], v[64:65]
  v_pk_mul_f32 v[34:35], v[34:35], v[66:67]
  v_pk_mul_f32 v[36:37], v[36:37], v[68:69]
  v_pk_mul_f32 v[38:39], v[38:39], v[70:71]
  v_pk_mul_f32 v[40:41], v[40:41], v[72:73]
  v_pk_mul_f32 v[42:43], v[42:43], v[74:75]
  v_pk_mul_f32 v[44:45], v[44:45], v[76:77]
  v_pk_mul_f32 v[46:47], v[46:47], v[78:79]
  v_pk_fma_f32 v[128:129], v[32:33], v[128:129], v[144:145]
  v_pk_fma_f32 v[130:131], v[34:35], v[130:131], v[146:147]
  v_pk_fma_f32 v[132:133], v[36:37], v[132:133], v[148:149]
  v_pk_fma_f32 v[134:135], v[38:39], v[134:135], v[150:151]
  v_pk_fma_f32 v[136:137], v[40:41], v[136:137], v[152:153]
  v_pk_fma_f32 v[138:139], v[42:43], v[138:139], v[154:155]
  v_pk_fma_f32 v[140:141], v[44:45], v[140:141], v[156:157]
  v_pk_fma_f32 v[142:143], v[46:47], v[142:143], v[158:159]
  v_cvt_pk_bf16_f32 v64, v128, v129
  v_cvt_pk_bf16_f32 v65, v130, v131
  v_cvt_pk_bf16_f32 v66, v132, v133
  v_cvt_pk_bf16_f32 v67, v134, v135
  v_cvt_pk_bf16_f32 v68, v136, v137
  v_cvt_pk_bf16_f32 v69, v138, v139
  v_cvt_pk_bf16_f32 v70, v140, v141
  v_cvt_pk_bf16_f32 v71, v142, v143
  v_permlane32_swap_b32 v64, v66
  v_permlane32_swap_b32 v65, v67
  v_permlane32_swap_b32 v68, v70
  v_permlane32_swap_b32 v69, v71
  v_lshrrev_b32 v17, 5, v1
  v_lshl_add_u32 v17, v17, 3, v230
  buffer_store_dwordx4 v[64:67], v17, s[40:43], s99 offen
  buffer_store_dwordx4 v[68:71], v17, s[40:43], s99 offen offset:32
L_end:
  s_endpgm
.section .rodata,"a"
.p2align 6
.amdhsa_kernel recurrent_scan__linear_kernel_hedgehog__glu_gated_reglu__prompt_kernel
  .amdhsa_next_free_vgpr 512
  .amdhsa_next_free_sgpr 102
  .amdhsa_accum_offset 256
  .amdhsa_group_segment_fixed_size 0
  .amdhsa_kernarg_size 88
  .amdhsa_user_sgpr_count 2
  .amdhsa_user_sgpr_kernarg_segment_ptr 1
  .amdhsa_system_sgpr_workgroup_id_x 1
  .amdhsa_float_denorm_mode_32 3
.end_amdhsa_kernel
```
